```python
import torch

def _softmax(x, axis=-1):
    return torch.softmax(x, dim=axis)
def _gelu(x):
    return torch.nn.functional.gelu(x, approximate="tanh")
def _silu(x):
    return torch.nn.functional.silu(x)
def _sigmoid(x):
    return torch.sigmoid(x)
def _layernorm(x, axis=-1, eps=1e-5):
    m = x.mean(dim=axis, keepdim=True)
    v = x.var(dim=axis, keepdim=True, unbiased=False)
    return (x - m) / torch.sqrt(v + eps)
def _scatter_add(tgt, idx, src, axis=0):
    return tgt.clone().index_add_(axis, idx, src)
def _segment_sum(src, seg, n):
    out = torch.zeros((n,) + src.shape[1:], dtype=src.dtype)
    return out.index_add_(0, seg, src)
def _pad(x, pw):
    flat = tuple(v for pair in reversed(pw) for v in pair)
    return torch.nn.functional.pad(x, flat)

kernel_name = 'standalone__gqa_softmax__decode'

def setup_inputs():

    _w = (lambda a: (lambda t: t.to(torch.bfloat16) if t.is_floating_point() else t)(torch.as_tensor(a)))
    B, Hq, Hkv, Sq, Sk, D = 1, 32, 32, 1, 32768, 128
    return {
        "q": _w((lambda *s: torch.randn(*s, dtype=torch.bfloat16) * 0.8)(B, Hq, Sq, D)),
        "k": _w((lambda *s: torch.randn(*s, dtype=torch.bfloat16) * 0.8)(B, Hkv, Sk, D)),
        "v": _w((lambda *s: torch.randn(*s, dtype=torch.bfloat16) * 0.05)(B, Hkv, Sk, D)),
    }

def reference(q, k, v):
    B, Hq, Sq, D = q.shape
    Hkv = k.shape[1]
    rep = Hq // Hkv
    k = (lambda x, n, axis: torch.repeat_interleave(x, n, dim=axis))(k, rep, axis=1)
    v = (lambda x, n, axis: torch.repeat_interleave(x, n, dim=axis))(v, rep, axis=1)
    scale = D ** -0.5
    scores = torch.einsum("bhqd,bhkd->bhqk", q, k) * scale
    p = _softmax(scores, axis=-1)
    return torch.einsum("bhqk,bhkd->bhqd", p, v)
```

```asm
; @launch grid=(256,1,1) block=(64,1,1) lds=46080
.amdgcn_target "amdgcn-amd-amdhsa--gfx950"
.text
.globl standalone__gqa_softmax__decode_kernel
.p2align 8
.type standalone__gqa_softmax__decode_kernel,@function
standalone__gqa_softmax__decode_kernel:
    s_cmp_ge_u32 s2, 256
    s_cbranch_scc1 L_end
    s_load_dwordx8 s[4:11], s[0:1], 0
    s_load_dwordx4 s[12:15], s[0:1], 32
    s_lshr_b32 s40, s2, 3
    s_and_b32 s41, s2, 7
    v_and_b32 v7, 3, v0
    v_lshlrev_b32 v3, 4, v7
    v_lshrrev_b32 v4, 4, v0
    v_lshl_add_u32 v3, v4, 6, v3
    v_bfe_u32 v11, v0, 2, 1
    v_mul_u32_u24 v11, 0x200, v11
    v_xor_b32 v56, v11, v3
    v_bfe_u32 v11, v0, 3, 1
    v_mul_u32_u24 v11, 0x400, v11
    v_xor_b32 v56, v11, v56
    v_xor_b32 v57, 8192, v56
    v_xor_b32 v58, 33024, v56
    v_xor_b32 v59, 41216, v56
    s_mov_b32 s44, s41
    s_mul_i32 s65, s40, 104
    s_add_u32 s68, s44, s65
    s_bfe_u32 s67, s68, 0x10000
    s_lshl_b32 s67, s67, 8
    s_bfe_u32 s47, s68, 0x10001
    s_lshl_b32 s47, s47, 14
    s_or_b32 s67, s67, s47
    s_bfe_u32 s47, s68, 0x10002
    s_lshl_b32 s47, s47, 17
    s_or_b32 s67, s67, s47
    s_bfe_u32 s47, s68, 0x10003
    s_lshl_b32 s47, s47, 16
    s_or_b32 s67, s67, s47
    s_bfe_u32 s47, s68, 0x20004
    s_lshl_b32 s47, s47, 18
    s_or_b32 s67, s67, s47
    s_bfe_u32 s47, s68, 0x20006
    s_lshl_b32 s47, s47, 21
    s_or_b32 s67, s67, s47
    s_lshl_b32 s47, s40, 23
    s_lshl_b32 s48, s40, 8
    s_mov_b32 s18, 0x800000
    s_mov_b32 s19, 0x00020000
    s_mov_b32 s26, 0x2000
    s_mov_b32 s27, 0x00020000
    s_waitcnt lgkmcnt(0)
    s_mov_b32 s24, s4
    s_mov_b32 s25, s5
    s_add_u32 s16, s6, s47
    s_addc_u32 s17, s7, 0
    buffer_load_dwordx4 v[36:39], v3, s[24:27], s48 offen
    v_xor_b32 v220, s67, v56
    v_xor_b32 v221, s67, v57
    v_xor_b32 v222, s67, v58
    v_xor_b32 v223, s67, v59
    buffer_load_dwordx4 v[64:67], v220, s[16:19], 0 offen nt
    buffer_load_dwordx4 v[68:71], v221, s[16:19], 0 offen nt
    buffer_load_dwordx4 v[72:75], v222, s[16:19], 0 offen nt
    buffer_load_dwordx4 v[76:79], v223, s[16:19], 0 offen nt
    s_xor_b32 s43, s67, 1048576
    v_xor_b32 v220, s43, v56
    v_xor_b32 v221, s43, v57
    v_xor_b32 v222, s43, v58
    v_xor_b32 v223, s43, v59
    buffer_load_dwordx4 v[80:83], v220, s[16:19], 0 offen nt
    buffer_load_dwordx4 v[84:87], v221, s[16:19], 0 offen nt
    buffer_load_dwordx4 v[88:91], v222, s[16:19], 0 offen nt
    buffer_load_dwordx4 v[92:95], v223, s[16:19], 0 offen nt
    s_xor_b32 s43, s67, 2048
    v_xor_b32 v220, s43, v56
    v_xor_b32 v221, s43, v57
    v_xor_b32 v222, s43, v58
    v_xor_b32 v223, s43, v59
    buffer_load_dwordx4 v[96:99], v220, s[16:19], 0 offen nt
    buffer_load_dwordx4 v[100:103], v221, s[16:19], 0 offen nt
    buffer_load_dwordx4 v[104:107], v222, s[16:19], 0 offen nt
    buffer_load_dwordx4 v[108:111], v223, s[16:19], 0 offen nt
    s_xor_b32 s43, s67, 1050624
    v_xor_b32 v220, s43, v56
    v_xor_b32 v221, s43, v57
    v_xor_b32 v222, s43, v58
    v_xor_b32 v223, s43, v59
    buffer_load_dwordx4 v[112:115], v220, s[16:19], 0 offen nt
    buffer_load_dwordx4 v[116:119], v221, s[16:19], 0 offen nt
    buffer_load_dwordx4 v[120:123], v222, s[16:19], 0 offen nt
    buffer_load_dwordx4 v[124:127], v223, s[16:19], 0 offen nt
    s_xor_b32 s43, s67, 4096
    v_xor_b32 v220, s43, v56
    v_xor_b32 v221, s43, v57
    v_xor_b32 v222, s43, v58
    v_xor_b32 v223, s43, v59
    buffer_load_dwordx4 v[128:131], v220, s[16:19], 0 offen nt
    buffer_load_dwordx4 v[132:135], v221, s[16:19], 0 offen nt
    buffer_load_dwordx4 v[136:139], v222, s[16:19], 0 offen nt
    buffer_load_dwordx4 v[140:143], v223, s[16:19], 0 offen nt
    s_xor_b32 s43, s67, 1052672
    v_xor_b32 v220, s43, v56
    v_xor_b32 v221, s43, v57
    v_xor_b32 v222, s43, v58
    v_xor_b32 v223, s43, v59
    buffer_load_dwordx4 v[144:147], v220, s[16:19], 0 offen nt
    buffer_load_dwordx4 v[148:151], v221, s[16:19], 0 offen nt
    buffer_load_dwordx4 v[152:155], v222, s[16:19], 0 offen nt
    buffer_load_dwordx4 v[156:159], v223, s[16:19], 0 offen nt
    s_xor_b32 s43, s67, 6144
    v_xor_b32 v220, s43, v56
    v_xor_b32 v221, s43, v57
    v_xor_b32 v222, s43, v58
    v_xor_b32 v223, s43, v59
    buffer_load_dwordx4 v[160:163], v220, s[16:19], 0 offen nt
    buffer_load_dwordx4 v[164:167], v221, s[16:19], 0 offen nt
    buffer_load_dwordx4 v[168:171], v222, s[16:19], 0 offen nt
    buffer_load_dwordx4 v[172:175], v223, s[16:19], 0 offen nt
    s_xor_b32 s43, s67, 1054720
    v_xor_b32 v220, s43, v56
    v_xor_b32 v221, s43, v57
    v_xor_b32 v222, s43, v58
    v_xor_b32 v223, s43, v59
    buffer_load_dwordx4 v[176:179], v220, s[16:19], 0 offen nt
    buffer_load_dwordx4 v[180:183], v221, s[16:19], 0 offen nt
    buffer_load_dwordx4 v[184:187], v222, s[16:19], 0 offen nt
    buffer_load_dwordx4 v[188:191], v223, s[16:19], 0 offen nt
    s_add_u32 s20, s8, s47
    s_addc_u32 s21, s9, 0
    v_and_b32 v5, 15, v0
    v_lshlrev_b32 v5, 4, v5
    v_bfe_u32 v11, v0, 4, 1
    v_mul_u32_u24 v11, 0x200, v11
    v_xor_b32 v60, v11, v5
    v_bfe_u32 v11, v0, 5, 1
    v_mul_u32_u24 v11, 0x400, v11
    v_xor_b32 v60, v11, v60
    v_xor_b32 v61, 8192, v60
    v_xor_b32 v62, 33024, v60
    v_xor_b32 v63, 41216, v60
    s_add_u32 s60, s14, 1048576
    s_addc_u32 s61, s15, 0
    s_mov_b32 s62, 139264
    s_mov_b32 s63, 0x00020000
    s_mul_i32 s49, s40, 4352
    s_mov_b32 s28, s14
    s_mov_b32 s29, s15
    s_mov_b32 s30, 786432
    s_mov_b32 s31, 0x00020000
    s_add_u32 s32, s10, s48
    s_addc_u32 s33, s11, 0
    s_mov_b32 s34, 256
    s_mov_b32 s35, 0x00020000
    s_mov_b32 s36, s12
    s_mov_b32 s37, s13
    s_mov_b32 s38, 256
    s_mov_b32 s39, 0x00020000
    s_lshl_b32 s64, s40, 2
    s_mul_i32 s66, s40, 8192
    s_mul_i32 s45, s40, 16384
    s_add_u32 s45, s45, 262144
    s_lshl_b32 s69, s41, 10
    s_add_u32 s94, s69, 1024
    s_and_b32 s94, s94, 8191
    s_add_u32 s94, s94, s66
    s_add_u32 s95, s69, 2048
    s_and_b32 s95, s95, 8191
    s_add_u32 s95, s95, s66
    s_add_u32 s96, s69, 3072
    s_and_b32 s96, s96, 8191
    s_add_u32 s96, s96, s66
    s_add_u32 s97, s69, 4096
    s_and_b32 s97, s97, 8191
    s_add_u32 s97, s97, s66
    s_add_u32 s98, s69, 5120
    s_and_b32 s98, s98, 8191
    s_add_u32 s98, s98, s66
    s_add_u32 s99, s69, 6144
    s_and_b32 s99, s99, 8191
    s_add_u32 s99, s99, s66
    s_add_u32 s100, s69, 7168
    s_and_b32 s100, s100, 8191
    s_add_u32 s100, s100, s66
    s_add_u32 s69, s69, s66
    v_lshlrev_b32 v2, 4, v0
    v_lshlrev_b32 v242, 3, v0
    v_mov_b32 v241, v242
    v_lshlrev_b32 v249, 2, v0
    v_add_u32 v248, s41, v242
    s_mov_b32 s91, 24
    s_mov_b32 s92, 0
    s_mov_b32 s93, -1
    v_mov_b32 v251, 0x40000000
    v_mov_b32 v250, 0x40000000
    v_mov_b32 v196, 0
    v_mov_b32 v197, 0
    v_mov_b32 v198, 0
    v_mov_b32 v199, 0
    v_and_b32 v1, 7, v0
    v_bfe_u32 v11, v0, 3, 3
    v_lshl_add_u32 v1, v11, 4, v1
    v_lshlrev_b32 v1, 1, v1
    v_mov_b32 v53, 0
    v_mov_b32 v55, 0
    v_mov_b32 v44, 0
    v_mov_b32 v48, 0
    v_mov_b32 v45, 0
    v_mov_b32 v49, 0
    v_mov_b32 v46, 0
    v_mov_b32 v50, 0
    v_mov_b32 v47, 0
    v_mov_b32 v51, 0
    s_cmp_lg_u32 s41, 0
    s_cbranch_scc1 L_noinit
    v_lshlrev_b32 v54, 2, v0
    s_mov_b64 exec, 7
    buffer_store_dword v53, v54, s[60:63], s49 offen sc0 sc1
    s_mov_b64 exec, -1
    s_add_u32 s47, s66, 4096
    buffer_store_dwordx4 v[44:47], v2, s[28:31], s66 offen sc1
    buffer_store_dwordx4 v[44:47], v2, s[28:31], s66 offen offset:1024 sc1
    buffer_store_dwordx4 v[44:47], v2, s[28:31], s66 offen offset:2048 sc1
    buffer_store_dwordx4 v[44:47], v2, s[28:31], s66 offen offset:3072 sc1
    buffer_store_dwordx4 v[44:47], v2, s[28:31], s47 offen sc1
    buffer_store_dwordx4 v[44:47], v2, s[28:31], s47 offen offset:1024 sc1
    buffer_store_dwordx4 v[44:47], v2, s[28:31], s47 offen offset:2048 sc1
    buffer_store_dwordx4 v[44:47], v2, s[28:31], s47 offen offset:3072 sc1
L_noinit:
    s_mov_b32 s42, 23
    s_mov_b32 s70, 8
    s_mov_b32 s71, 0
    s_mov_b32 s55, 0
    s_mov_b32 s90, 0
    s_mov_b32 s22, 0x40000000
    s_mov_b32 s23, 0x40000000
    s_mov_b32 s54, s49
    s_mov_b32 s88, 0x53627180
    s_mov_b32 s89, 0x192a3b
    s_mov_b32 s82, 0x22222222
    s_mov_b32 s83, 0x22222222
    s_mov_b32 s84, 0x44444444
    s_mov_b32 s85, 0x44444444
    s_mov_b32 s86, 0x88888888
    s_mov_b32 s87, 0x88888888
    s_cmp_eq_u32 s41, 0
    s_cselect_b32 s46, 19, 3
    v_bfe_u32 v4, v0, 2, 2
    v_and_b32 v11, 1, v0
    v_lshlrev_b32 v11, 4, v11
    v_mov_b32 v6, 0xffff
    v_lshlrev_b32 v6, v11, v6
    v_bfe_u32 v11, v0, 1, 2
    v_cmp_eq_u32 vcc, 0, v11
    s_nop 1
    v_cndmask_b32 v12, 0, v6, vcc
    v_cmp_eq_u32 vcc, 1, v11
    s_nop 1
    v_cndmask_b32 v13, 0, v6, vcc
    v_cmp_eq_u32 vcc, 2, v11
    s_nop 1
    v_cndmask_b32 v14, 0, v6, vcc
    v_cmp_eq_u32 vcc, 3, v11
    s_nop 1
    v_cndmask_b32 v15, 0, v6, vcc
    v_mov_b32 v10, 0x3e0293ee
    v_mov_b32 v8, 0
    v_mov_b32 v240, 0xff7fffff
    s_waitcnt vmcnt(32)
    v_cmp_eq_u32 vcc, 0, v4
    s_nop 1
    v_cndmask_b32 v16, 0, v36, vcc
    v_cndmask_b32 v17, 0, v37, vcc
    v_cndmask_b32 v18, 0, v38, vcc
    v_cndmask_b32 v19, 0, v39, vcc
    v_cmp_eq_u32 vcc, 1, v4
    s_nop 1
    v_cndmask_b32 v20, 0, v36, vcc
    v_cndmask_b32 v21, 0, v37, vcc
    v_cndmask_b32 v22, 0, v38, vcc
    v_cndmask_b32 v23, 0, v39, vcc
    v_cmp_eq_u32 vcc, 2, v4
    s_nop 1
    v_cndmask_b32 v24, 0, v36, vcc
    v_cndmask_b32 v25, 0, v37, vcc
    v_cndmask_b32 v26, 0, v38, vcc
    v_cndmask_b32 v27, 0, v39, vcc
    v_cmp_eq_u32 vcc, 3, v4
    s_nop 1
    v_cndmask_b32 v28, 0, v36, vcc
    v_cndmask_b32 v29, 0, v37, vcc
    v_cndmask_b32 v30, 0, v38, vcc
    v_cndmask_b32 v31, 0, v39, vcc
    s_nop 1
.p2align 6
L_A:
    s_cmp_le_u32 s42, s46
    s_cbranch_scc1 L_ctlA
L_retA:
    s_add_u32 s44, s44, 8
    s_sub_u32 s42, s42, 1
    s_add_u32 s68, s44, s65
    s_bfe_u32 s67, s68, 0x10000
    s_lshl_b32 s67, s67, 8
    s_bfe_u32 s47, s68, 0x10001
    s_lshl_b32 s47, s47, 14
    s_or_b32 s67, s67, s47
    s_bfe_u32 s47, s68, 0x10002
    s_lshl_b32 s47, s47, 17
    s_or_b32 s67, s67, s47
    s_bfe_u32 s47, s68, 0x10003
    s_lshl_b32 s47, s47, 16
    s_or_b32 s67, s67, s47
    s_bfe_u32 s47, s68, 0x20004
    s_lshl_b32 s47, s47, 18
    s_or_b32 s67, s67, s47
    s_bfe_u32 s47, s68, 0x20006
    s_lshl_b32 s47, s47, 21
    s_or_b32 s67, s67, s47
    s_waitcnt vmcnt(28)
    v_mfma_f32_16x16x32_bf16 v[32:35], v[64:67], v[16:19], 0
    v_mfma_f32_16x16x32_bf16 v[32:35], v[68:71], v[20:23], v[32:35]
    v_mfma_f32_16x16x32_bf16 v[32:35], v[72:75], v[24:27], v[32:35]
    v_mfma_f32_16x16x32_bf16 v[32:35], v[76:79], v[28:31], v[32:35]
    v_xor_b32 v220, s67, v56
    v_xor_b32 v221, s67, v57
    v_xor_b32 v222, s67, v58
    v_xor_b32 v223, s67, v59
    buffer_load_dwordx4 v[64:67], v220, s[16:19], 0 offen nt
    buffer_load_dwordx4 v[68:71], v221, s[16:19], 0 offen nt
    buffer_load_dwordx4 v[72:75], v222, s[16:19], 0 offen nt
    buffer_load_dwordx4 v[76:79], v223, s[16:19], 0 offen nt
    s_nop 1
    v_mov_b32_dpp v3, v32 quad_perm:[0,0,0,0] row_mask:0xf bank_mask:0xf
    v_mov_b32_dpp v4, v33 quad_perm:[1,1,1,1] row_mask:0xf bank_mask:0xf
    s_nop 0
    v_add_f32_dpp v3, v34, v3 quad_perm:[2,2,2,2] row_mask:0xf bank_mask:0xf
    v_add_f32_dpp v4, v35, v4 quad_perm:[3,3,3,3] row_mask:0xf bank_mask:0xf
    v_add_f32 v224, v3, v4
    s_waitcnt vmcnt(28)
    v_mfma_f32_16x16x32_bf16 v[32:35], v[80:83], v[16:19], 0
    v_mfma_f32_16x16x32_bf16 v[32:35], v[84:87], v[20:23], v[32:35]
    v_mfma_f32_16x16x32_bf16 v[32:35], v[88:91], v[24:27], v[32:35]
    v_mfma_f32_16x16x32_bf16 v[32:35], v[92:95], v[28:31], v[32:35]
    s_xor_b32 s43, s67, 1048576
    v_xor_b32 v220, s43, v56
    v_xor_b32 v221, s43, v57
    v_xor_b32 v222, s43, v58
    v_xor_b32 v223, s43, v59
    buffer_load_dwordx4 v[80:83], v220, s[16:19], 0 offen nt
    buffer_load_dwordx4 v[84:87], v221, s[16:19], 0 offen nt
    buffer_load_dwordx4 v[88:91], v222, s[16:19], 0 offen nt
    buffer_load_dwordx4 v[92:95], v223, s[16:19], 0 offen nt
    s_nop 1
    v_mov_b32_dpp v3, v32 quad_perm:[0,0,0,0] row_mask:0xf bank_mask:0xf
    v_mov_b32_dpp v4, v33 quad_perm:[1,1,1,1] row_mask:0xf bank_mask:0xf
    s_nop 0
    v_add_f32_dpp v3, v34, v3 quad_perm:[2,2,2,2] row_mask:0xf bank_mask:0xf
    v_add_f32_dpp v4, v35, v4 quad_perm:[3,3,3,3] row_mask:0xf bank_mask:0xf
    v_add_f32 v5, v3, v4
    v_cndmask_b32 v224, v224, v5, s[82:83]
    s_waitcnt vmcnt(28)
    v_mfma_f32_16x16x32_bf16 v[32:35], v[96:99], v[16:19], 0
    v_mfma_f32_16x16x32_bf16 v[32:35], v[100:103], v[20:23], v[32:35]
    v_mfma_f32_16x16x32_bf16 v[32:35], v[104:107], v[24:27], v[32:35]
    v_mfma_f32_16x16x32_bf16 v[32:35], v[108:111], v[28:31], v[32:35]
    s_xor_b32 s43, s67, 2048
    v_xor_b32 v220, s43, v56
    v_xor_b32 v221, s43, v57
    v_xor_b32 v222, s43, v58
    v_xor_b32 v223, s43, v59
    buffer_load_dwordx4 v[96:99], v220, s[16:19], 0 offen nt
    buffer_load_dwordx4 v[100:103], v221, s[16:19], 0 offen nt
    buffer_load_dwordx4 v[104:107], v222, s[16:19], 0 offen nt
    buffer_load_dwordx4 v[108:111], v223, s[16:19], 0 offen nt
    s_nop 1
    v_mov_b32_dpp v3, v32 quad_perm:[0,0,0,0] row_mask:0xf bank_mask:0xf
    v_mov_b32_dpp v4, v33 quad_perm:[1,1,1,1] row_mask:0xf bank_mask:0xf
    s_nop 0
    v_add_f32_dpp v3, v34, v3 quad_perm:[2,2,2,2] row_mask:0xf bank_mask:0xf
    v_add_f32_dpp v4, v35, v4 quad_perm:[3,3,3,3] row_mask:0xf bank_mask:0xf
    v_add_f32 v5, v3, v4
    v_cndmask_b32 v224, v224, v5, s[84:85]
    s_waitcnt vmcnt(28)
    v_mfma_f32_16x16x32_bf16 v[32:35], v[112:115], v[16:19], 0
    v_mfma_f32_16x16x32_bf16 v[32:35], v[116:119], v[20:23], v[32:35]
    v_mfma_f32_16x16x32_bf16 v[32:35], v[120:123], v[24:27], v[32:35]
    v_mfma_f32_16x16x32_bf16 v[32:35], v[124:127], v[28:31], v[32:35]
    s_xor_b32 s43, s67, 1050624
    v_xor_b32 v220, s43, v56
    v_xor_b32 v221, s43, v57
    v_xor_b32 v222, s43, v58
    v_xor_b32 v223, s43, v59
    buffer_load_dwordx4 v[112:115], v220, s[16:19], 0 offen nt
    buffer_load_dwordx4 v[116:119], v221, s[16:19], 0 offen nt
    buffer_load_dwordx4 v[120:123], v222, s[16:19], 0 offen nt
    buffer_load_dwordx4 v[124:127], v223, s[16:19], 0 offen nt
    s_nop 1
    v_mov_b32_dpp v3, v32 quad_perm:[0,0,0,0] row_mask:0xf bank_mask:0xf
    v_mov_b32_dpp v4, v33 quad_perm:[1,1,1,1] row_mask:0xf bank_mask:0xf
    s_nop 0
    v_add_f32_dpp v3, v34, v3 quad_perm:[2,2,2,2] row_mask:0xf bank_mask:0xf
    v_add_f32_dpp v4, v35, v4 quad_perm:[3,3,3,3] row_mask:0xf bank_mask:0xf
    v_add_f32 v5, v3, v4
    v_cndmask_b32 v224, v224, v5, s[86:87]
    s_waitcnt vmcnt(28)
    v_mfma_f32_16x16x32_bf16 v[32:35], v[128:131], v[16:19], 0
    v_mfma_f32_16x16x32_bf16 v[32:35], v[132:135], v[20:23], v[32:35]
    v_mfma_f32_16x16x32_bf16 v[32:35], v[136:139], v[24:27], v[32:35]
    v_mfma_f32_16x16x32_bf16 v[32:35], v[140:143], v[28:31], v[32:35]
    s_xor_b32 s43, s67, 4096
    v_xor_b32 v220, s43, v56
    v_xor_b32 v221, s43, v57
    v_xor_b32 v222, s43, v58
    v_xor_b32 v223, s43, v59
    buffer_load_dwordx4 v[128:131], v220, s[16:19], 0 offen nt
    buffer_load_dwordx4 v[132:135], v221, s[16:19], 0 offen nt
    buffer_load_dwordx4 v[136:139], v222, s[16:19], 0 offen nt
    buffer_load_dwordx4 v[140:143], v223, s[16:19], 0 offen nt
    s_nop 1
    v_mov_b32_dpp v3, v32 quad_perm:[0,0,0,0] row_mask:0xf bank_mask:0xf
    v_mov_b32_dpp v4, v33 quad_perm:[1,1,1,1] row_mask:0xf bank_mask:0xf
    s_nop 0
    v_add_f32_dpp v3, v34, v3 quad_perm:[2,2,2,2] row_mask:0xf bank_mask:0xf
    v_add_f32_dpp v4, v35, v4 quad_perm:[3,3,3,3] row_mask:0xf bank_mask:0xf
    v_add_f32 v225, v3, v4
    s_waitcnt vmcnt(28)
    v_mfma_f32_16x16x32_bf16 v[32:35], v[144:147], v[16:19], 0
    v_mfma_f32_16x16x32_bf16 v[32:35], v[148:151], v[20:23], v[32:35]
    v_mfma_f32_16x16x32_bf16 v[32:35], v[152:155], v[24:27], v[32:35]
    v_mfma_f32_16x16x32_bf16 v[32:35], v[156:159], v[28:31], v[32:35]
    s_xor_b32 s43, s67, 1052672
    v_xor_b32 v220, s43, v56
    v_xor_b32 v221, s43, v57
    v_xor_b32 v222, s43, v58
    v_xor_b32 v223, s43, v59
    buffer_load_dwordx4 v[144:147], v220, s[16:19], 0 offen nt
    buffer_load_dwordx4 v[148:151], v221, s[16:19], 0 offen nt
    buffer_load_dwordx4 v[152:155], v222, s[16:19], 0 offen nt
    buffer_load_dwordx4 v[156:159], v223, s[16:19], 0 offen nt
    s_nop 1
    v_mov_b32_dpp v3, v32 quad_perm:[0,0,0,0] row_mask:0xf bank_mask:0xf
    v_mov_b32_dpp v4, v33 quad_perm:[1,1,1,1] row_mask:0xf bank_mask:0xf
    s_nop 0
    v_add_f32_dpp v3, v34, v3 quad_perm:[2,2,2,2] row_mask:0xf bank_mask:0xf
    v_add_f32_dpp v4, v35, v4 quad_perm:[3,3,3,3] row_mask:0xf bank_mask:0xf
    v_add_f32 v5, v3, v4
    v_cndmask_b32 v225, v225, v5, s[82:83]
    s_waitcnt vmcnt(28)
    v_mfma_f32_16x16x32_bf16 v[32:35], v[160:163], v[16:19], 0
    v_mfma_f32_16x16x32_bf16 v[32:35], v[164:167], v[20:23], v[32:35]
    v_mfma_f32_16x16x32_bf16 v[32:35], v[168:171], v[24:27], v[32:35]
    v_mfma_f32_16x16x32_bf16 v[32:35], v[172:175], v[28:31], v[32:35]
    s_xor_b32 s43, s67, 6144
    v_xor_b32 v220, s43, v56
    v_xor_b32 v221, s43, v57
    v_xor_b32 v222, s43, v58
    v_xor_b32 v223, s43, v59
    buffer_load_dwordx4 v[160:163], v220, s[16:19], 0 offen nt
    buffer_load_dwordx4 v[164:167], v221, s[16:19], 0 offen nt
    buffer_load_dwordx4 v[168:171], v222, s[16:19], 0 offen nt
    buffer_load_dwordx4 v[172:175], v223, s[16:19], 0 offen nt
    s_nop 1
    v_mov_b32_dpp v3, v32 quad_perm:[0,0,0,0] row_mask:0xf bank_mask:0xf
    v_mov_b32_dpp v4, v33 quad_perm:[1,1,1,1] row_mask:0xf bank_mask:0xf
    s_nop 0
    v_add_f32_dpp v3, v34, v3 quad_perm:[2,2,2,2] row_mask:0xf bank_mask:0xf
    v_add_f32_dpp v4, v35, v4 quad_perm:[3,3,3,3] row_mask:0xf bank_mask:0xf
    v_add_f32 v5, v3, v4
    v_cndmask_b32 v225, v225, v5, s[84:85]
    s_waitcnt vmcnt(28)
    v_mfma_f32_16x16x32_bf16 v[32:35], v[176:179], v[16:19], 0
    v_mfma_f32_16x16x32_bf16 v[32:35], v[180:183], v[20:23], v[32:35]
    v_mfma_f32_16x16x32_bf16 v[32:35], v[184:187], v[24:27], v[32:35]
    v_mfma_f32_16x16x32_bf16 v[32:35], v[188:191], v[28:31], v[32:35]
    s_xor_b32 s43, s67, 1054720
    v_xor_b32 v220, s43, v56
    v_xor_b32 v221, s43, v57
    v_xor_b32 v222, s43, v58
    v_xor_b32 v223, s43, v59
    buffer_load_dwordx4 v[176:179], v220, s[16:19], 0 offen nt
    buffer_load_dwordx4 v[180:183], v221, s[16:19], 0 offen nt
    buffer_load_dwordx4 v[184:187], v222, s[16:19], 0 offen nt
    buffer_load_dwordx4 v[188:191], v223, s[16:19], 0 offen nt
    s_nop 1
    v_mov_b32_dpp v3, v32 quad_perm:[0,0,0,0] row_mask:0xf bank_mask:0xf
    v_mov_b32_dpp v4, v33 quad_perm:[1,1,1,1] row_mask:0xf bank_mask:0xf
    s_nop 0
    v_add_f32_dpp v3, v34, v3 quad_perm:[2,2,2,2] row_mask:0xf bank_mask:0xf
    v_add_f32_dpp v4, v35, v4 quad_perm:[3,3,3,3] row_mask:0xf bank_mask:0xf
    v_add_f32 v5, v3, v4
    v_cndmask_b32 v225, v225, v5, s[86:87]
    ds_write_b64 v241, v[224:225]
    v_max3_f32 v240, v240, v224, v225
    v_add_u32 v241, 512, v241
    s_cmp_lg_u32 s42, 0
    s_cbranch_scc1 L_A
L_B:
    s_waitcnt vmcnt(32)
    v_readfirstlane_b32 s47, v53
    s_cmp_lg_u32 s93, -1
    s_cbranch_scc1 L_pendB
    s_cmp_lt_u32 s47, 28
    s_cbranch_scc1 L_pairB
    s_add_u32 s93, s47, 28
L_pendB:
    s_mov_b32 s47, s93
    s_mov_b32 s93, -1
    v_mov_b32 v53, 1
    s_mov_b64 exec, 1
    buffer_atomic_add v53, off, s[60:63], s49 sc0
    s_mov_b64 exec, -1
L_pretB:
    v_add_u32 v243, s22, v249
    s_cmp_eq_u32 s22, 0x40000000
    s_cbranch_scc1 L_nopkB
    v_max_f32 v6, v224, v225
    s_nop 1
    v_max_f32_dpp v11, v6, v6 quad_perm:[1,0,3,2] row_mask:0xf bank_mask:0xf
    s_nop 1
    v_max_f32_dpp v11, v11, v11 quad_perm:[2,3,0,1] row_mask:0xf bank_mask:0xf
    s_nop 1
    v_max_f32_dpp v11, v11, v11 row_ror:4 row_mask:0xf bank_mask:0xf
    s_nop 1
    v_max_f32_dpp v11, v11, v11 row_ror:8 row_mask:0xf bank_mask:0xf
    s_nop 1
    v_readlane_b32 s50, v11, 0
    v_readlane_b32 s51, v11, 16
    v_readlane_b32 s52, v11, 32
    v_readlane_b32 s53, v11, 48
    s_nop 1
    v_mov_b32 v11, s50
    v_max_f32 v11, s51, v11
    v_max_f32 v11, s52, v11
    v_max_f32 v11, s53, v11
    v_max_f32 v11, 0xff7fffff, v11
    v_mul_f32 v11, -v10, v11
    v_fma_f32 v3, v224, v10, v11
    v_fma_f32 v4, v225, v10, v11
    v_readfirstlane_b32 s50, v11
    v_exp_f32 v3, v3
    v_exp_f32 v4, v4
    s_nop 0
    v_cvt_pk_bf16_f32 v224, v3, v4
    v_and_b32 v224, 0x7fffffff, v224
    s_mov_b32 exec_lo, s50
    s_mov_b32 exec_hi, 0
    v_or_b32 v224, 0x80000000, v224
    s_mov_b64 exec, -1
    s_nop 0
    v_mov_b32_dpp v225, v224 quad_perm:[1,1,1,1] row_mask:0xf bank_mask:0xf
    v_mov_b32_dpp v226, v224 quad_perm:[2,2,2,2] row_mask:0xf bank_mask:0xf
    v_mov_b32_dpp v227, v224 quad_perm:[3,3,3,3] row_mask:0xf bank_mask:0xf
L_nopkB:
    s_mov_b32 s22, s23
    s_cmp_lg_u32 s93, -1
    s_cbranch_scc1 L_holdB
    s_mov_b32 exec_lo, 0x11111111
    s_mov_b32 exec_hi, 0x11111111
    buffer_store_dwordx4 v[196:199], v250, s[28:31], 0 offen sc1 nt
    buffer_store_dwordx4 v[224:227], v243, s[28:31], 0 offen sc1 nt
    s_mov_b64 exec, -1
    v_mov_b32 v250, v251
L_hretB:
    s_cmp_ge_u32 s47, 64
    s_cbranch_scc1 L_swV
    s_add_u32 s44, s47, 192
    s_lshl_b32 s23, s47, 8
    s_add_u32 s23, s23, s45
L_retB:
    s_add_u32 s68, s44, s65
    s_bfe_u32 s67, s68, 0x10000
    s_lshl_b32 s67, s67, 8
    s_bfe_u32 s47, s68, 0x10001
    s_lshl_b32 s47, s47, 14
    s_or_b32 s67, s67, s47
    s_bfe_u32 s47, s68, 0x10002
    s_lshl_b32 s47, s47, 17
    s_or_b32 s67, s67, s47
    s_bfe_u32 s47, s68, 0x10003
    s_lshl_b32 s47, s47, 16
    s_or_b32 s67, s67, s47
    s_bfe_u32 s47, s68, 0x20004
    s_lshl_b32 s47, s47, 18
    s_or_b32 s67, s67, s47
    s_bfe_u32 s47, s68, 0x20006
    s_lshl_b32 s47, s47, 21
    s_or_b32 s67, s67, s47
    s_waitcnt vmcnt(31)
    v_mfma_f32_16x16x32_bf16 v[32:35], v[64:67], v[16:19], 0
    v_mfma_f32_16x16x32_bf16 v[32:35], v[68:71], v[20:23], v[32:35]
    v_mfma_f32_16x16x32_bf16 v[32:35], v[72:75], v[24:27], v[32:35]
    v_mfma_f32_16x16x32_bf16 v[32:35], v[76:79], v[28:31], v[32:35]
    v_xor_b32 v220, s67, v56
    v_xor_b32 v221, s67, v57
    v_xor_b32 v222, s67, v58
    v_xor_b32 v223, s67, v59
    buffer_load_dwordx4 v[64:67], v220, s[16:19], 0 offen nt
    buffer_load_dwordx4 v[68:71], v221, s[16:19], 0 offen nt
    buffer_load_dwordx4 v[72:75], v222, s[16:19], 0 offen nt
    buffer_load_dwordx4 v[76:79], v223, s[16:19], 0 offen nt
    s_nop 1
    v_mov_b32_dpp v3, v32 quad_perm:[0,0,0,0] row_mask:0xf bank_mask:0xf
    v_mov_b32_dpp v4, v33 quad_perm:[1,1,1,1] row_mask:0xf bank_mask:0xf
    s_nop 0
    v_add_f32_dpp v3, v34, v3 quad_perm:[2,2,2,2] row_mask:0xf bank_mask:0xf
    v_add_f32_dpp v4, v35, v4 quad_perm:[3,3,3,3] row_mask:0xf bank_mask:0xf
    v_add_f32 v224, v3, v4
    s_waitcnt vmcnt(31)
    v_mfma_f32_16x16x32_bf16 v[32:35], v[80:83], v[16:19], 0
    v_mfma_f32_16x16x32_bf16 v[32:35], v[84:87], v[20:23], v[32:35]
    v_mfma_f32_16x16x32_bf16 v[32:35], v[88:91], v[24:27], v[32:35]
    v_mfma_f32_16x16x32_bf16 v[32:35], v[92:95], v[28:31], v[32:35]
    s_xor_b32 s43, s67, 1048576
    v_xor_b32 v220, s43, v56
    v_xor_b32 v221, s43, v57
    v_xor_b32 v222, s43, v58
    v_xor_b32 v223, s43, v59
    buffer_load_dwordx4 v[80:83], v220, s[16:19], 0 offen nt
    buffer_load_dwordx4 v[84:87], v221, s[16:19], 0 offen nt
    buffer_load_dwordx4 v[88:91], v222, s[16:19], 0 offen nt
    buffer_load_dwordx4 v[92:95], v223, s[16:19], 0 offen nt
    s_nop 1
    v_mov_b32_dpp v3, v32 quad_perm:[0,0,0,0] row_mask:0xf bank_mask:0xf
    v_mov_b32_dpp v4, v33 quad_perm:[1,1,1,1] row_mask:0xf bank_mask:0xf
    s_nop 0
    v_add_f32_dpp v3, v34, v3 quad_perm:[2,2,2,2] row_mask:0xf bank_mask:0xf
    v_add_f32_dpp v4, v35, v4 quad_perm:[3,3,3,3] row_mask:0xf bank_mask:0xf
    v_add_f32 v5, v3, v4
    v_cndmask_b32 v224, v224, v5, s[82:83]
    s_waitcnt vmcnt(31)
    v_mfma_f32_16x16x32_bf16 v[32:35], v[96:99], v[16:19], 0
    v_mfma_f32_16x16x32_bf16 v[32:35], v[100:103], v[20:23], v[32:35]
    v_mfma_f32_16x16x32_bf16 v[32:35], v[104:107], v[24:27], v[32:35]
    v_mfma_f32_16x16x32_bf16 v[32:35], v[108:111], v[28:31], v[32:35]
    s_xor_b32 s43, s67, 2048
    v_xor_b32 v220, s43, v56
    v_xor_b32 v221, s43, v57
    v_xor_b32 v222, s43, v58
    v_xor_b32 v223, s43, v59
    buffer_load_dwordx4 v[96:99], v220, s[16:19], 0 offen nt
    buffer_load_dwordx4 v[100:103], v221, s[16:19], 0 offen nt
    buffer_load_dwordx4 v[104:107], v222, s[16:19], 0 offen nt
    buffer_load_dwordx4 v[108:111], v223, s[16:19], 0 offen nt
    s_nop 1
    v_mov_b32_dpp v3, v32 quad_perm:[0,0,0,0] row_mask:0xf bank_mask:0xf
    v_mov_b32_dpp v4, v33 quad_perm:[1,1,1,1] row_mask:0xf bank_mask:0xf
    s_nop 0
    v_add_f32_dpp v3, v34, v3 quad_perm:[2,2,2,2] row_mask:0xf bank_mask:0xf
    v_add_f32_dpp v4, v35, v4 quad_perm:[3,3,3,3] row_mask:0xf bank_mask:0xf
    v_add_f32 v5, v3, v4
    v_cndmask_b32 v224, v224, v5, s[84:85]
    s_waitcnt vmcnt(31)
    v_mfma_f32_16x16x32_bf16 v[32:35], v[112:115], v[16:19], 0
    v_mfma_f32_16x16x32_bf16 v[32:35], v[116:119], v[20:23], v[32:35]
    v_mfma_f32_16x16x32_bf16 v[32:35], v[120:123], v[24:27], v[32:35]
    v_mfma_f32_16x16x32_bf16 v[32:35], v[124:127], v[28:31], v[32:35]
    s_xor_b32 s43, s67, 1050624
    v_xor_b32 v220, s43, v56
    v_xor_b32 v221, s43, v57
    v_xor_b32 v222, s43, v58
    v_xor_b32 v223, s43, v59
    buffer_load_dwordx4 v[112:115], v220, s[16:19], 0 offen nt
    buffer_load_dwordx4 v[116:119], v221, s[16:19], 0 offen nt
    buffer_load_dwordx4 v[120:123], v222, s[16:19], 0 offen nt
    buffer_load_dwordx4 v[124:127], v223, s[16:19], 0 offen nt
    s_nop 1
    v_mov_b32_dpp v3, v32 quad_perm:[0,0,0,0] row_mask:0xf bank_mask:0xf
    v_mov_b32_dpp v4, v33 quad_perm:[1,1,1,1] row_mask:0xf bank_mask:0xf
    s_nop 0
    v_add_f32_dpp v3, v34, v3 quad_perm:[2,2,2,2] row_mask:0xf bank_mask:0xf
    v_add_f32_dpp v4, v35, v4 quad_perm:[3,3,3,3] row_mask:0xf bank_mask:0xf
    v_add_f32 v5, v3, v4
    v_cndmask_b32 v224, v224, v5, s[86:87]
    s_waitcnt vmcnt(31)
    v_mfma_f32_16x16x32_bf16 v[32:35], v[128:131], v[16:19], 0
    v_mfma_f32_16x16x32_bf16 v[32:35], v[132:135], v[20:23], v[32:35]
    v_mfma_f32_16x16x32_bf16 v[32:35], v[136:139], v[24:27], v[32:35]
    v_mfma_f32_16x16x32_bf16 v[32:35], v[140:143], v[28:31], v[32:35]
    s_xor_b32 s43, s67, 4096
    v_xor_b32 v220, s43, v56
    v_xor_b32 v221, s43, v57
    v_xor_b32 v222, s43, v58
    v_xor_b32 v223, s43, v59
    buffer_load_dwordx4 v[128:131], v220, s[16:19], 0 offen nt
    buffer_load_dwordx4 v[132:135], v221, s[16:19], 0 offen nt
    buffer_load_dwordx4 v[136:139], v222, s[16:19], 0 offen nt
    buffer_load_dwordx4 v[140:143], v223, s[16:19], 0 offen nt
    s_nop 1
    v_mov_b32_dpp v3, v32 quad_perm:[0,0,0,0] row_mask:0xf bank_mask:0xf
    v_mov_b32_dpp v4, v33 quad_perm:[1,1,1,1] row_mask:0xf bank_mask:0xf
    s_nop 0
    v_add_f32_dpp v3, v34, v3 quad_perm:[2,2,2,2] row_mask:0xf bank_mask:0xf
    v_add_f32_dpp v4, v35, v4 quad_perm:[3,3,3,3] row_mask:0xf bank_mask:0xf
    v_add_f32 v225, v3, v4
    s_waitcnt vmcnt(31)
    v_mfma_f32_16x16x32_bf16 v[32:35], v[144:147], v[16:19], 0
    v_mfma_f32_16x16x32_bf16 v[32:35], v[148:151], v[20:23], v[32:35]
    v_mfma_f32_16x16x32_bf16 v[32:35], v[152:155], v[24:27], v[32:35]
    v_mfma_f32_16x16x32_bf16 v[32:35], v[156:159], v[28:31], v[32:35]
    s_xor_b32 s43, s67, 1052672
    v_xor_b32 v220, s43, v56
    v_xor_b32 v221, s43, v57
    v_xor_b32 v222, s43, v58
    v_xor_b32 v223, s43, v59
    buffer_load_dwordx4 v[144:147], v220, s[16:19], 0 offen nt
    buffer_load_dwordx4 v[148:151], v221, s[16:19], 0 offen nt
    buffer_load_dwordx4 v[152:155], v222, s[16:19], 0 offen nt
    buffer_load_dwordx4 v[156:159], v223, s[16:19], 0 offen nt
    s_nop 1
    v_mov_b32_dpp v3, v32 quad_perm:[0,0,0,0] row_mask:0xf bank_mask:0xf
    v_mov_b32_dpp v4, v33 quad_perm:[1,1,1,1] row_mask:0xf bank_mask:0xf
    s_nop 0
    v_add_f32_dpp v3, v34, v3 quad_perm:[2,2,2,2] row_mask:0xf bank_mask:0xf
    v_add_f32_dpp v4, v35, v4 quad_perm:[3,3,3,3] row_mask:0xf bank_mask:0xf
    v_add_f32 v5, v3, v4
    v_cndmask_b32 v225, v225, v5, s[82:83]
    s_waitcnt vmcnt(31)
    v_mfma_f32_16x16x32_bf16 v[32:35], v[160:163], v[16:19], 0
    v_mfma_f32_16x16x32_bf16 v[32:35], v[164:167], v[20:23], v[32:35]
    v_mfma_f32_16x16x32_bf16 v[32:35], v[168:171], v[24:27], v[32:35]
    v_mfma_f32_16x16x32_bf16 v[32:35], v[172:175], v[28:31], v[32:35]
    s_xor_b32 s43, s67, 6144
    v_xor_b32 v220, s43, v56
    v_xor_b32 v221, s43, v57
    v_xor_b32 v222, s43, v58
    v_xor_b32 v223, s43, v59
    buffer_load_dwordx4 v[160:163], v220, s[16:19], 0 offen nt
    buffer_load_dwordx4 v[164:167], v221, s[16:19], 0 offen nt
    buffer_load_dwordx4 v[168:171], v222, s[16:19], 0 offen nt
    buffer_load_dwordx4 v[172:175], v223, s[16:19], 0 offen nt
    s_nop 1
    v_mov_b32_dpp v3, v32 quad_perm:[0,0,0,0] row_mask:0xf bank_mask:0xf
    v_mov_b32_dpp v4, v33 quad_perm:[1,1,1,1] row_mask:0xf bank_mask:0xf
    s_nop 0
    v_add_f32_dpp v3, v34, v3 quad_perm:[2,2,2,2] row_mask:0xf bank_mask:0xf
    v_add_f32_dpp v4, v35, v4 quad_perm:[3,3,3,3] row_mask:0xf bank_mask:0xf
    v_add_f32 v5, v3, v4
    v_cndmask_b32 v225, v225, v5, s[84:85]
    s_waitcnt vmcnt(31)
    v_mfma_f32_16x16x32_bf16 v[32:35], v[176:179], v[16:19], 0
    v_mfma_f32_16x16x32_bf16 v[32:35], v[180:183], v[20:23], v[32:35]
    v_mfma_f32_16x16x32_bf16 v[32:35], v[184:187], v[24:27], v[32:35]
    v_mfma_f32_16x16x32_bf16 v[32:35], v[188:191], v[28:31], v[32:35]
    s_xor_b32 s43, s67, 1054720
    v_xor_b32 v220, s43, v56
    v_xor_b32 v221, s43, v57
    v_xor_b32 v222, s43, v58
    v_xor_b32 v223, s43, v59
    buffer_load_dwordx4 v[176:179], v220, s[16:19], 0 offen nt
    buffer_load_dwordx4 v[180:183], v221, s[16:19], 0 offen nt
    buffer_load_dwordx4 v[184:187], v222, s[16:19], 0 offen nt
    buffer_load_dwordx4 v[188:191], v223, s[16:19], 0 offen nt
    s_nop 1
    v_mov_b32_dpp v3, v32 quad_perm:[0,0,0,0] row_mask:0xf bank_mask:0xf
    v_mov_b32_dpp v4, v33 quad_perm:[1,1,1,1] row_mask:0xf bank_mask:0xf
    s_nop 0
    v_add_f32_dpp v3, v34, v3 quad_perm:[2,2,2,2] row_mask:0xf bank_mask:0xf
    v_add_f32_dpp v4, v35, v4 quad_perm:[3,3,3,3] row_mask:0xf bank_mask:0xf
    v_add_f32 v5, v3, v4
    v_cndmask_b32 v225, v225, v5, s[86:87]
    ds_write_b64 v241, v[224:225]
    v_max3_f32 v240, v240, v224, v225
    v_add_u32 v241, 512, v241
    s_cmp_eq_u32 s90, 0
    s_cbranch_scc1 L_B
    v_add_u32 v243, s22, v249
    s_cmp_eq_u32 s22, 0x40000000
    s_cbranch_scc1 L_nopkE
    v_max_f32 v6, v224, v225
    s_nop 1
    v_max_f32_dpp v11, v6, v6 quad_perm:[1,0,3,2] row_mask:0xf bank_mask:0xf
    s_nop 1
    v_max_f32_dpp v11, v11, v11 quad_perm:[2,3,0,1] row_mask:0xf bank_mask:0xf
    s_nop 1
    v_max_f32_dpp v11, v11, v11 row_ror:4 row_mask:0xf bank_mask:0xf
    s_nop 1
    v_max_f32_dpp v11, v11, v11 row_ror:8 row_mask:0xf bank_mask:0xf
    s_nop 1
    v_readlane_b32 s50, v11, 0
    v_readlane_b32 s51, v11, 16
    v_readlane_b32 s52, v11, 32
    v_readlane_b32 s53, v11, 48
    s_nop 1
    v_mov_b32 v11, s50
    v_max_f32 v11, s51, v11
    v_max_f32 v11, s52, v11
    v_max_f32 v11, s53, v11
    v_max_f32 v11, 0xff7fffff, v11
    v_mul_f32 v11, -v10, v11
    v_fma_f32 v3, v224, v10, v11
    v_fma_f32 v4, v225, v10, v11
    v_readfirstlane_b32 s50, v11
    v_exp_f32 v3, v3
    v_exp_f32 v4, v4
    s_nop 0
    v_cvt_pk_bf16_f32 v224, v3, v4
    v_and_b32 v224, 0x7fffffff, v224
    s_mov_b32 exec_lo, s50
    s_mov_b32 exec_hi, 0
    v_or_b32 v224, 0x80000000, v224
    s_mov_b64 exec, -1
    s_nop 0
    v_mov_b32_dpp v225, v224 quad_perm:[1,1,1,1] row_mask:0xf bank_mask:0xf
    v_mov_b32_dpp v226, v224 quad_perm:[2,2,2,2] row_mask:0xf bank_mask:0xf
    v_mov_b32_dpp v227, v224 quad_perm:[3,3,3,3] row_mask:0xf bank_mask:0xf
L_nopkE:
    s_mov_b32 exec_lo, 0x11111111
    s_mov_b32 exec_hi, 0x11111111
    buffer_store_dwordx4 v[196:199], v250, s[28:31], 0 offen sc1 nt
    buffer_store_dwordx4 v[224:227], v243, s[28:31], 0 offen sc1 nt
    s_mov_b64 exec, -1
    v_mov_b32 v250, v251
    v_add_u32 v241, 512, v242
    s_sub_u32 s42, s91, 1
    s_sub_u32 s46, s91, 3
    s_mov_b32 s90, 0
    v_max_f32_dpp v11, v240, v240 quad_perm:[1,0,3,2] row_mask:0xf bank_mask:0xf
    s_nop 1
    v_max_f32_dpp v11, v11, v11 quad_perm:[2,3,0,1] row_mask:0xf bank_mask:0xf
    s_nop 1
    v_max_f32_dpp v11, v11, v11 row_ror:4 row_mask:0xf bank_mask:0xf
    s_nop 1
    v_max_f32_dpp v11, v11, v11 row_ror:8 row_mask:0xf bank_mask:0xf
    s_nop 1
    v_readlane_b32 s50, v11, 0
    v_readlane_b32 s51, v11, 16
    v_readlane_b32 s52, v11, 32
    v_readlane_b32 s53, v11, 48
    s_nop 1
    v_mov_b32 v11, s50
    v_max_f32 v11, s51, v11
    v_max_f32 v11, s52, v11
    v_max_f32 v11, s53, v11
    ds_read_b64 v[226:227], v242
    v_mul_f32 v9, -v10, v11
L_C:
    s_cmp_le_u32 s42, s46
    s_cbranch_scc1 L_ctlC
L_retC:
    s_add_u32 s44, s44, 8
    s_sub_u32 s42, s42, 1
    s_add_u32 s68, s44, s65
    s_bfe_u32 s67, s68, 0x10000
    s_lshl_b32 s67, s67, 8
    s_bfe_u32 s47, s68, 0x10001
    s_lshl_b32 s47, s47, 14
    s_or_b32 s67, s67, s47
    s_bfe_u32 s47, s68, 0x10002
    s_lshl_b32 s47, s47, 17
    s_or_b32 s67, s67, s47
    s_bfe_u32 s47, s68, 0x10003
    s_lshl_b32 s47, s47, 16
    s_or_b32 s67, s67, s47
    s_bfe_u32 s47, s68, 0x20004
    s_lshl_b32 s47, s47, 18
    s_or_b32 s67, s67, s47
    s_bfe_u32 s47, s68, 0x20006
    s_lshl_b32 s47, s47, 21
    s_or_b32 s67, s67, s47
    s_waitcnt lgkmcnt(0)
    v_fma_f32 v3, v226, v10, v9
    v_fma_f32 v4, v227, v10, v9
    ds_read_b64 v[226:227], v241
    v_add_u32 v241, 512, v241
    v_exp_f32 v3, v3
    v_exp_f32 v4, v4
    s_nop 0
    v_cvt_pk_bf16_f32 v224, v3, v3
    v_cvt_pk_bf16_f32 v225, v4, v4
    v_add_f32 v8, v8, v3
    v_add_f32 v8, v8, v4
    v_mov_b32_dpp v228, v224 row_shr:4 row_mask:0xf bank_mask:0xf bound_ctrl:0
    v_mov_b32_dpp v230, v224 row_shl:4 row_mask:0xf bank_mask:0xf bound_ctrl:0
    v_mov_b32_dpp v229, v225 row_shr:4 row_mask:0xf bank_mask:0xf bound_ctrl:0
    v_mov_b32_dpp v231, v225 row_shl:4 row_mask:0xf bank_mask:0xf bound_ctrl:0
    v_and_b32_dpp v36, v224, v12 quad_perm:[0,0,0,0] row_mask:0xf bank_mask:0xf
    v_and_b32_dpp v37, v224, v13 quad_perm:[0,0,0,0] row_mask:0xf bank_mask:0xf
    v_and_b32_dpp v42, v224, v14 quad_perm:[0,0,0,0] row_mask:0xf bank_mask:0xf
    v_and_b32_dpp v43, v224, v15 quad_perm:[0,0,0,0] row_mask:0xf bank_mask:0xf
    v_and_b32_dpp v38, v228, v14 quad_perm:[0,0,0,0] row_mask:0xf bank_mask:0xf
    v_and_b32_dpp v39, v228, v15 quad_perm:[0,0,0,0] row_mask:0xf bank_mask:0xf
    v_and_b32_dpp v40, v230, v12 quad_perm:[0,0,0,0] row_mask:0xf bank_mask:0xf
    v_and_b32_dpp v41, v230, v13 quad_perm:[0,0,0,0] row_mask:0xf bank_mask:0xf
    s_waitcnt vmcnt(28)
    v_mfma_f32_16x16x32_bf16 v[44:47], v[64:67], v[36:39], v[44:47]
    v_mfma_f32_16x16x32_bf16 v[48:51], v[72:75], v[36:39], v[48:51]
    v_mfma_f32_16x16x32_bf16 v[44:47], v[68:71], v[40:43], v[44:47]
    v_mfma_f32_16x16x32_bf16 v[48:51], v[76:79], v[40:43], v[48:51]
    v_xor_b32 v220, s67, v56
    v_xor_b32 v221, s67, v57
    v_xor_b32 v222, s67, v58
    v_xor_b32 v223, s67, v59
    buffer_load_dwordx4 v[64:67], v220, s[16:19], 0 offen nt
    buffer_load_dwordx4 v[68:71], v221, s[16:19], 0 offen nt
    buffer_load_dwordx4 v[72:75], v222, s[16:19], 0 offen nt
    buffer_load_dwordx4 v[76:79], v223, s[16:19], 0 offen nt
    v_and_b32_dpp v232, v224, v12 quad_perm:[1,1,1,1] row_mask:0xf bank_mask:0xf
    v_and_b32_dpp v233, v224, v13 quad_perm:[1,1,1,1] row_mask:0xf bank_mask:0xf
    v_and_b32_dpp v238, v224, v14 quad_perm:[1,1,1,1] row_mask:0xf bank_mask:0xf
    v_and_b32_dpp v239, v224, v15 quad_perm:[1,1,1,1] row_mask:0xf bank_mask:0xf
    v_and_b32_dpp v234, v228, v14 quad_perm:[1,1,1,1] row_mask:0xf bank_mask:0xf
    v_and_b32_dpp v235, v228, v15 quad_perm:[1,1,1,1] row_mask:0xf bank_mask:0xf
    v_and_b32_dpp v236, v230, v12 quad_perm:[1,1,1,1] row_mask:0xf bank_mask:0xf
    v_and_b32_dpp v237, v230, v13 quad_perm:[1,1,1,1] row_mask:0xf bank_mask:0xf
    s_waitcnt vmcnt(28)
    v_mfma_f32_16x16x32_bf16 v[44:47], v[80:83], v[232:235], v[44:47]
    v_mfma_f32_16x16x32_bf16 v[48:51], v[88:91], v[232:235], v[48:51]
    v_mfma_f32_16x16x32_bf16 v[44:47], v[84:87], v[236:239], v[44:47]
    v_mfma_f32_16x16x32_bf16 v[48:51], v[92:95], v[236:239], v[48:51]
    s_xor_b32 s43, s67, 1048576
    v_xor_b32 v220, s43, v56
    v_xor_b32 v221, s43, v57
    v_xor_b32 v222, s43, v58
    v_xor_b32 v223, s43, v59
    buffer_load_dwordx4 v[80:83], v220, s[16:19], 0 offen nt
    buffer_load_dwordx4 v[84:87], v221, s[16:19], 0 offen nt
    buffer_load_dwordx4 v[88:91], v222, s[16:19], 0 offen nt
    buffer_load_dwordx4 v[92:95], v223, s[16:19], 0 offen nt
    v_and_b32_dpp v36, v224, v12 quad_perm:[2,2,2,2] row_mask:0xf bank_mask:0xf
    v_and_b32_dpp v37, v224, v13 quad_perm:[2,2,2,2] row_mask:0xf bank_mask:0xf
    v_and_b32_dpp v42, v224, v14 quad_perm:[2,2,2,2] row_mask:0xf bank_mask:0xf
    v_and_b32_dpp v43, v224, v15 quad_perm:[2,2,2,2] row_mask:0xf bank_mask:0xf
    v_and_b32_dpp v38, v228, v14 quad_perm:[2,2,2,2] row_mask:0xf bank_mask:0xf
    v_and_b32_dpp v39, v228, v15 quad_perm:[2,2,2,2] row_mask:0xf bank_mask:0xf
    v_and_b32_dpp v40, v230, v12 quad_perm:[2,2,2,2] row_mask:0xf bank_mask:0xf
    v_and_b32_dpp v41, v230, v13 quad_perm:[2,2,2,2] row_mask:0xf bank_mask:0xf
    s_waitcnt vmcnt(28)
    v_mfma_f32_16x16x32_bf16 v[44:47], v[96:99], v[36:39], v[44:47]
    v_mfma_f32_16x16x32_bf16 v[48:51], v[104:107], v[36:39], v[48:51]
    v_mfma_f32_16x16x32_bf16 v[44:47], v[100:103], v[40:43], v[44:47]
    v_mfma_f32_16x16x32_bf16 v[48:51], v[108:111], v[40:43], v[48:51]
    s_xor_b32 s43, s67, 2048
    v_xor_b32 v220, s43, v56
    v_xor_b32 v221, s43, v57
    v_xor_b32 v222, s43, v58
    v_xor_b32 v223, s43, v59
    buffer_load_dwordx4 v[96:99], v220, s[16:19], 0 offen nt
    buffer_load_dwordx4 v[100:103], v221, s[16:19], 0 offen nt
    buffer_load_dwordx4 v[104:107], v222, s[16:19], 0 offen nt
    buffer_load_dwordx4 v[108:111], v223, s[16:19], 0 offen nt
    v_and_b32_dpp v232, v224, v12 quad_perm:[3,3,3,3] row_mask:0xf bank_mask:0xf
    v_and_b32_dpp v233, v224, v13 quad_perm:[3,3,3,3] row_mask:0xf bank_mask:0xf
    v_and_b32_dpp v238, v224, v14 quad_perm:[3,3,3,3] row_mask:0xf bank_mask:0xf
    v_and_b32_dpp v239, v224, v15 quad_perm:[3,3,3,3] row_mask:0xf bank_mask:0xf
    v_and_b32_dpp v234, v228, v14 quad_perm:[3,3,3,3] row_mask:0xf bank_mask:0xf
    v_and_b32_dpp v235, v228, v15 quad_perm:[3,3,3,3] row_mask:0xf bank_mask:0xf
    v_and_b32_dpp v236, v230, v12 quad_perm:[3,3,3,3] row_mask:0xf bank_mask:0xf
    v_and_b32_dpp v237, v230, v13 quad_perm:[3,3,3,3] row_mask:0xf bank_mask:0xf
    s_waitcnt vmcnt(28)
    v_mfma_f32_16x16x32_bf16 v[44:47], v[112:115], v[232:235], v[44:47]
    v_mfma_f32_16x16x32_bf16 v[48:51], v[120:123], v[232:235], v[48:51]
    v_mfma_f32_16x16x32_bf16 v[44:47], v[116:119], v[236:239], v[44:47]
    v_mfma_f32_16x16x32_bf16 v[48:51], v[124:127], v[236:239], v[48:51]
    s_xor_b32 s43, s67, 1050624
    v_xor_b32 v220, s43, v56
    v_xor_b32 v221, s43, v57
    v_xor_b32 v222, s43, v58
    v_xor_b32 v223, s43, v59
    buffer_load_dwordx4 v[112:115], v220, s[16:19], 0 offen nt
    buffer_load_dwordx4 v[116:119], v221, s[16:19], 0 offen nt
    buffer_load_dwordx4 v[120:123], v222, s[16:19], 0 offen nt
    buffer_load_dwordx4 v[124:127], v223, s[16:19], 0 offen nt
    v_and_b32_dpp v36, v225, v12 quad_perm:[0,0,0,0] row_mask:0xf bank_mask:0xf
    v_and_b32_dpp v37, v225, v13 quad_perm:[0,0,0,0] row_mask:0xf bank_mask:0xf
    v_and_b32_dpp v42, v225, v14 quad_perm:[0,0,0,0] row_mask:0xf bank_mask:0xf
    v_and_b32_dpp v43, v225, v15 quad_perm:[0,0,0,0] row_mask:0xf bank_mask:0xf
    v_and_b32_dpp v38, v229, v14 quad_perm:[0,0,0,0] row_mask:0xf bank_mask:0xf
    v_and_b32_dpp v39, v229, v15 quad_perm:[0,0,0,0] row_mask:0xf bank_mask:0xf
    v_and_b32_dpp v40, v231, v12 quad_perm:[0,0,0,0] row_mask:0xf bank_mask:0xf
    v_and_b32_dpp v41, v231, v13 quad_perm:[0,0,0,0] row_mask:0xf bank_mask:0xf
    s_waitcnt vmcnt(28)
    v_mfma_f32_16x16x32_bf16 v[44:47], v[128:131], v[36:39], v[44:47]
    v_mfma_f32_16x16x32_bf16 v[48:51], v[136:139], v[36:39], v[48:51]
    v_mfma_f32_16x16x32_bf16 v[44:47], v[132:135], v[40:43], v[44:47]
    v_mfma_f32_16x16x32_bf16 v[48:51], v[140:143], v[40:43], v[48:51]
    s_xor_b32 s43, s67, 4096
    v_xor_b32 v220, s43, v56
    v_xor_b32 v221, s43, v57
    v_xor_b32 v222, s43, v58
    v_xor_b32 v223, s43, v59
    buffer_load_dwordx4 v[128:131], v220, s[16:19], 0 offen nt
    buffer_load_dwordx4 v[132:135], v221, s[16:19], 0 offen nt
    buffer_load_dwordx4 v[136:139], v222, s[16:19], 0 offen nt
    buffer_load_dwordx4 v[140:143], v223, s[16:19], 0 offen nt
    v_and_b32_dpp v232, v225, v12 quad_perm:[1,1,1,1] row_mask:0xf bank_mask:0xf
    v_and_b32_dpp v233, v225, v13 quad_perm:[1,1,1,1] row_mask:0xf bank_mask:0xf
    v_and_b32_dpp v238, v225, v14 quad_perm:[1,1,1,1] row_mask:0xf bank_mask:0xf
    v_and_b32_dpp v239, v225, v15 quad_perm:[1,1,1,1] row_mask:0xf bank_mask:0xf
    v_and_b32_dpp v234, v229, v14 quad_perm:[1,1,1,1] row_mask:0xf bank_mask:0xf
    v_and_b32_dpp v235, v229, v15 quad_perm:[1,1,1,1] row_mask:0xf bank_mask:0xf
    v_and_b32_dpp v236, v231, v12 quad_perm:[1,1,1,1] row_mask:0xf bank_mask:0xf
    v_and_b32_dpp v237, v231, v13 quad_perm:[1,1,1,1] row_mask:0xf bank_mask:0xf
    s_waitcnt vmcnt(28)
    v_mfma_f32_16x16x32_bf16 v[44:47], v[144:147], v[232:235], v[44:47]
    v_mfma_f32_16x16x32_bf16 v[48:51], v[152:155], v[232:235], v[48:51]
    v_mfma_f32_16x16x32_bf16 v[44:47], v[148:151], v[236:239], v[44:47]
    v_mfma_f32_16x16x32_bf16 v[48:51], v[156:159], v[236:239], v[48:51]
    s_xor_b32 s43, s67, 1052672
    v_xor_b32 v220, s43, v56
    v_xor_b32 v221, s43, v57
    v_xor_b32 v222, s43, v58
    v_xor_b32 v223, s43, v59
    buffer_load_dwordx4 v[144:147], v220, s[16:19], 0 offen nt
    buffer_load_dwordx4 v[148:151], v221, s[16:19], 0 offen nt
    buffer_load_dwordx4 v[152:155], v222, s[16:19], 0 offen nt
    buffer_load_dwordx4 v[156:159], v223, s[16:19], 0 offen nt
    v_and_b32_dpp v36, v225, v12 quad_perm:[2,2,2,2] row_mask:0xf bank_mask:0xf
    v_and_b32_dpp v37, v225, v13 quad_perm:[2,2,2,2] row_mask:0xf bank_mask:0xf
    v_and_b32_dpp v42, v225, v14 quad_perm:[2,2,2,2] row_mask:0xf bank_mask:0xf
    v_and_b32_dpp v43, v225, v15 quad_perm:[2,2,2,2] row_mask:0xf bank_mask:0xf
    v_and_b32_dpp v38, v229, v14 quad_perm:[2,2,2,2] row_mask:0xf bank_mask:0xf
    v_and_b32_dpp v39, v229, v15 quad_perm:[2,2,2,2] row_mask:0xf bank_mask:0xf
    v_and_b32_dpp v40, v231, v12 quad_perm:[2,2,2,2] row_mask:0xf bank_mask:0xf
    v_and_b32_dpp v41, v231, v13 quad_perm:[2,2,2,2] row_mask:0xf bank_mask:0xf
    s_waitcnt vmcnt(28)
    v_mfma_f32_16x16x32_bf16 v[44:47], v[160:163], v[36:39], v[44:47]
    v_mfma_f32_16x16x32_bf16 v[48:51], v[168:171], v[36:39], v[48:51]
    v_mfma_f32_16x16x32_bf16 v[44:47], v[164:167], v[40:43], v[44:47]
    v_mfma_f32_16x16x32_bf16 v[48:51], v[172:175], v[40:43], v[48:51]
    s_xor_b32 s43, s67, 6144
    v_xor_b32 v220, s43, v56
    v_xor_b32 v221, s43, v57
    v_xor_b32 v222, s43, v58
    v_xor_b32 v223, s43, v59
    buffer_load_dwordx4 v[160:163], v220, s[16:19], 0 offen nt
    buffer_load_dwordx4 v[164:167], v221, s[16:19], 0 offen nt
    buffer_load_dwordx4 v[168:171], v222, s[16:19], 0 offen nt
    buffer_load_dwordx4 v[172:175], v223, s[16:19], 0 offen nt
    v_and_b32_dpp v232, v225, v12 quad_perm:[3,3,3,3] row_mask:0xf bank_mask:0xf
    v_and_b32_dpp v233, v225, v13 quad_perm:[3,3,3,3] row_mask:0xf bank_mask:0xf
    v_and_b32_dpp v238, v225, v14 quad_perm:[3,3,3,3] row_mask:0xf bank_mask:0xf
    v_and_b32_dpp v239, v225, v15 quad_perm:[3,3,3,3] row_mask:0xf bank_mask:0xf
    v_and_b32_dpp v234, v229, v14 quad_perm:[3,3,3,3] row_mask:0xf bank_mask:0xf
    v_and_b32_dpp v235, v229, v15 quad_perm:[3,3,3,3] row_mask:0xf bank_mask:0xf
    v_and_b32_dpp v236, v231, v12 quad_perm:[3,3,3,3] row_mask:0xf bank_mask:0xf
    v_and_b32_dpp v237, v231, v13 quad_perm:[3,3,3,3] row_mask:0xf bank_mask:0xf
    s_waitcnt vmcnt(28)
    v_mfma_f32_16x16x32_bf16 v[44:47], v[176:179], v[232:235], v[44:47]
    v_mfma_f32_16x16x32_bf16 v[48:51], v[184:187], v[232:235], v[48:51]
    v_mfma_f32_16x16x32_bf16 v[44:47], v[180:183], v[236:239], v[44:47]
    v_mfma_f32_16x16x32_bf16 v[48:51], v[188:191], v[236:239], v[48:51]
    s_xor_b32 s43, s67, 1054720
    v_xor_b32 v220, s43, v56
    v_xor_b32 v221, s43, v57
    v_xor_b32 v222, s43, v58
    v_xor_b32 v223, s43, v59
    buffer_load_dwordx4 v[176:179], v220, s[16:19], 0 offen nt
    buffer_load_dwordx4 v[180:183], v221, s[16:19], 0 offen nt
    buffer_load_dwordx4 v[184:187], v222, s[16:19], 0 offen nt
    buffer_load_dwordx4 v[188:191], v223, s[16:19], 0 offen nt
    s_cmp_lg_u32 s42, 0
    s_cbranch_scc1 L_C
    s_waitcnt vmcnt(32) lgkmcnt(0)
    v_readfirstlane_b32 s47, v53
    v_fma_f32 v3, v226, v10, v9
    v_fma_f32 v4, v227, v10, v9
    v_exp_f32 v3, v3
    v_exp_f32 v4, v4
    s_branch L_Dmid
L_D:
    s_waitcnt vmcnt(32)
    v_readfirstlane_b32 s47, v53
    v_cmp_gt_i32 vcc, 0, v226
    v_lshlrev_b32 v3, 16, v226
    v_and_b32 v4, 0x7fff0000, v226
    s_mov_b32 s50, vcc_lo
    v_subrev_f32 v6, vcc_lo, v9
    v_cmp_lt_f32 vcc, 0, v6
    s_cbranch_vccnz L_rare_D
L_back_D:
    v_exp_f32 v6, v6
    s_nop 0
    v_mul_f32 v3, v3, v6
    v_mul_f32 v4, v4, v6
L_Dmid:
    s_cmp_lg_u32 s93, -1
    s_cbranch_scc1 L_pendD
    s_cmp_lt_u32 s47, 16
    s_cbranch_scc1 L_pairD
    s_add_u32 s93, s47, 16
L_pendD:
    s_mov_b32 s47, s93
    s_mov_b32 s93, -1
    s_cmp_ge_u32 s47, 60
    s_cbranch_scc1 L_tail
L_retD:
    v_mov_b32 v53, 1
    s_mov_b64 exec, 1
    buffer_atomic_add v53, off, s[60:63], s54 offset:8 sc0
    s_mov_b64 exec, -1
L_pretD:
    s_add_u32 s44, s47, 192
    s_lshl_b32 s47, s47, 8
    s_add_u32 s47, s47, s45
    buffer_load_dword v226, v249, s[28:31], s47 offen sc1 nt
    s_add_u32 s68, s44, s65
    s_bfe_u32 s67, s68, 0x10000
    s_lshl_b32 s67, s67, 8
    s_bfe_u32 s47, s68, 0x10001
    s_lshl_b32 s47, s47, 14
    s_or_b32 s67, s67, s47
    s_bfe_u32 s47, s68, 0x10002
    s_lshl_b32 s47, s47, 17
    s_or_b32 s67, s67, s47
    s_bfe_u32 s47, s68, 0x10003
    s_lshl_b32 s47, s47, 16
    s_or_b32 s67, s67, s47
    s_bfe_u32 s47, s68, 0x20004
    s_lshl_b32 s47, s47, 18
    s_or_b32 s67, s67, s47
    s_bfe_u32 s47, s68, 0x20006
    s_lshl_b32 s47, s47, 21
    s_or_b32 s67, s67, s47
    s_xor_b32 s67, s67, s71
    s_nop 0
    v_cvt_pk_bf16_f32 v224, v3, v3
    v_cvt_pk_bf16_f32 v225, v4, v4
    v_add_f32 v8, v8, v3
    v_add_f32 v8, v8, v4
    v_mov_b32_dpp v228, v224 row_shr:4 row_mask:0xf bank_mask:0xf bound_ctrl:0
    v_mov_b32_dpp v230, v224 row_shl:4 row_mask:0xf bank_mask:0xf bound_ctrl:0
    v_mov_b32_dpp v229, v225 row_shr:4 row_mask:0xf bank_mask:0xf bound_ctrl:0
    v_mov_b32_dpp v231, v225 row_shl:4 row_mask:0xf bank_mask:0xf bound_ctrl:0
    v_and_b32_dpp v36, v224, v12 quad_perm:[0,0,0,0] row_mask:0xf bank_mask:0xf
    v_and_b32_dpp v37, v224, v13 quad_perm:[0,0,0,0] row_mask:0xf bank_mask:0xf
    v_and_b32_dpp v42, v224, v14 quad_perm:[0,0,0,0] row_mask:0xf bank_mask:0xf
    v_and_b32_dpp v43, v224, v15 quad_perm:[0,0,0,0] row_mask:0xf bank_mask:0xf
    v_and_b32_dpp v38, v228, v14 quad_perm:[0,0,0,0] row_mask:0xf bank_mask:0xf
    v_and_b32_dpp v39, v228, v15 quad_perm:[0,0,0,0] row_mask:0xf bank_mask:0xf
    v_and_b32_dpp v40, v230, v12 quad_perm:[0,0,0,0] row_mask:0xf bank_mask:0xf
    v_and_b32_dpp v41, v230, v13 quad_perm:[0,0,0,0] row_mask:0xf bank_mask:0xf
    s_waitcnt vmcnt(30)
    v_mfma_f32_16x16x32_bf16 v[44:47], v[64:67], v[36:39], v[44:47]
    v_mfma_f32_16x16x32_bf16 v[48:51], v[72:75], v[36:39], v[48:51]
    v_mfma_f32_16x16x32_bf16 v[44:47], v[68:71], v[40:43], v[44:47]
    v_mfma_f32_16x16x32_bf16 v[48:51], v[76:79], v[40:43], v[48:51]
    s_cmp_lt_u32 0, s70
    s_cselect_b32 s43, s67, 0x800000
    v_xor_b32 v220, s43, v56
    v_xor_b32 v221, s43, v57
    v_xor_b32 v222, s43, v58
    v_xor_b32 v223, s43, v59
    buffer_load_dwordx4 v[64:67], v220, s[16:19], 0 offen nt
    buffer_load_dwordx4 v[68:71], v221, s[16:19], 0 offen nt
    buffer_load_dwordx4 v[72:75], v222, s[16:19], 0 offen nt
    buffer_load_dwordx4 v[76:79], v223, s[16:19], 0 offen nt
    v_and_b32_dpp v232, v224, v12 quad_perm:[1,1,1,1] row_mask:0xf bank_mask:0xf
    v_and_b32_dpp v233, v224, v13 quad_perm:[1,1,1,1] row_mask:0xf bank_mask:0xf
    v_and_b32_dpp v238, v224, v14 quad_perm:[1,1,1,1] row_mask:0xf bank_mask:0xf
    v_and_b32_dpp v239, v224, v15 quad_perm:[1,1,1,1] row_mask:0xf bank_mask:0xf
    v_and_b32_dpp v234, v228, v14 quad_perm:[1,1,1,1] row_mask:0xf bank_mask:0xf
    v_and_b32_dpp v235, v228, v15 quad_perm:[1,1,1,1] row_mask:0xf bank_mask:0xf
    v_and_b32_dpp v236, v230, v12 quad_perm:[1,1,1,1] row_mask:0xf bank_mask:0xf
    v_and_b32_dpp v237, v230, v13 quad_perm:[1,1,1,1] row_mask:0xf bank_mask:0xf
    s_waitcnt vmcnt(30)
    v_mfma_f32_16x16x32_bf16 v[44:47], v[80:83], v[232:235], v[44:47]
    v_mfma_f32_16x16x32_bf16 v[48:51], v[88:91], v[232:235], v[48:51]
    v_mfma_f32_16x16x32_bf16 v[44:47], v[84:87], v[236:239], v[44:47]
    v_mfma_f32_16x16x32_bf16 v[48:51], v[92:95], v[236:239], v[48:51]
    s_xor_b32 s43, s67, 1048576
    s_cmp_lt_u32 1, s70
    s_cselect_b32 s43, s43, 0x800000
    v_xor_b32 v220, s43, v56
    v_xor_b32 v221, s43, v57
    v_xor_b32 v222, s43, v58
    v_xor_b32 v223, s43, v59
    buffer_load_dwordx4 v[80:83], v220, s[16:19], 0 offen nt
    buffer_load_dwordx4 v[84:87], v221, s[16:19], 0 offen nt
    buffer_load_dwordx4 v[88:91], v222, s[16:19], 0 offen nt
    buffer_load_dwordx4 v[92:95], v223, s[16:19], 0 offen nt
    v_and_b32_dpp v36, v224, v12 quad_perm:[2,2,2,2] row_mask:0xf bank_mask:0xf
    v_and_b32_dpp v37, v224, v13 quad_perm:[2,2,2,2] row_mask:0xf bank_mask:0xf
    v_and_b32_dpp v42, v224, v14 quad_perm:[2,2,2,2] row_mask:0xf bank_mask:0xf
    v_and_b32_dpp v43, v224, v15 quad_perm:[2,2,2,2] row_mask:0xf bank_mask:0xf
    v_and_b32_dpp v38, v228, v14 quad_perm:[2,2,2,2] row_mask:0xf bank_mask:0xf
    v_and_b32_dpp v39, v228, v15 quad_perm:[2,2,2,2] row_mask:0xf bank_mask:0xf
    v_and_b32_dpp v40, v230, v12 quad_perm:[2,2,2,2] row_mask:0xf bank_mask:0xf
    v_and_b32_dpp v41, v230, v13 quad_perm:[2,2,2,2] row_mask:0xf bank_mask:0xf
    s_waitcnt vmcnt(30)
    v_mfma_f32_16x16x32_bf16 v[44:47], v[96:99], v[36:39], v[44:47]
    v_mfma_f32_16x16x32_bf16 v[48:51], v[104:107], v[36:39], v[48:51]
    v_mfma_f32_16x16x32_bf16 v[44:47], v[100:103], v[40:43], v[44:47]
    v_mfma_f32_16x16x32_bf16 v[48:51], v[108:111], v[40:43], v[48:51]
    s_xor_b32 s43, s67, 2048
    s_cmp_lt_u32 2, s70
    s_cselect_b32 s43, s43, 0x800000
    v_xor_b32 v220, s43, v56
    v_xor_b32 v221, s43, v57
    v_xor_b32 v222, s43, v58
    v_xor_b32 v223, s43, v59
    buffer_load_dwordx4 v[96:99], v220, s[16:19], 0 offen nt
    buffer_load_dwordx4 v[100:103], v221, s[16:19], 0 offen nt
    buffer_load_dwordx4 v[104:107], v222, s[16:19], 0 offen nt
    buffer_load_dwordx4 v[108:111], v223, s[16:19], 0 offen nt
    v_and_b32_dpp v232, v224, v12 quad_perm:[3,3,3,3] row_mask:0xf bank_mask:0xf
    v_and_b32_dpp v233, v224, v13 quad_perm:[3,3,3,3] row_mask:0xf bank_mask:0xf
    v_and_b32_dpp v238, v224, v14 quad_perm:[3,3,3,3] row_mask:0xf bank_mask:0xf
    v_and_b32_dpp v239, v224, v15 quad_perm:[3,3,3,3] row_mask:0xf bank_mask:0xf
    v_and_b32_dpp v234, v228, v14 quad_perm:[3,3,3,3] row_mask:0xf bank_mask:0xf
    v_and_b32_dpp v235, v228, v15 quad_perm:[3,3,3,3] row_mask:0xf bank_mask:0xf
    v_and_b32_dpp v236, v230, v12 quad_perm:[3,3,3,3] row_mask:0xf bank_mask:0xf
    v_and_b32_dpp v237, v230, v13 quad_perm:[3,3,3,3] row_mask:0xf bank_mask:0xf
    s_waitcnt vmcnt(30)
    v_mfma_f32_16x16x32_bf16 v[44:47], v[112:115], v[232:235], v[44:47]
    v_mfma_f32_16x16x32_bf16 v[48:51], v[120:123], v[232:235], v[48:51]
    v_mfma_f32_16x16x32_bf16 v[44:47], v[116:119], v[236:239], v[44:47]
    v_mfma_f32_16x16x32_bf16 v[48:51], v[124:127], v[236:239], v[48:51]
    s_xor_b32 s43, s67, 1050624
    s_cmp_lt_u32 3, s70
    s_cselect_b32 s43, s43, 0x800000
    v_xor_b32 v220, s43, v56
    v_xor_b32 v221, s43, v57
    v_xor_b32 v222, s43, v58
    v_xor_b32 v223, s43, v59
    buffer_load_dwordx4 v[112:115], v220, s[16:19], 0 offen nt
    buffer_load_dwordx4 v[116:119], v221, s[16:19], 0 offen nt
    buffer_load_dwordx4 v[120:123], v222, s[16:19], 0 offen nt
    buffer_load_dwordx4 v[124:127], v223, s[16:19], 0 offen nt
    v_and_b32_dpp v36, v225, v12 quad_perm:[0,0,0,0] row_mask:0xf bank_mask:0xf
    v_and_b32_dpp v37, v225, v13 quad_perm:[0,0,0,0] row_mask:0xf bank_mask:0xf
    v_and_b32_dpp v42, v225, v14 quad_perm:[0,0,0,0] row_mask:0xf bank_mask:0xf
    v_and_b32_dpp v43, v225, v15 quad_perm:[0,0,0,0] row_mask:0xf bank_mask:0xf
    v_and_b32_dpp v38, v229, v14 quad_perm:[0,0,0,0] row_mask:0xf bank_mask:0xf
    v_and_b32_dpp v39, v229, v15 quad_perm:[0,0,0,0] row_mask:0xf bank_mask:0xf
    v_and_b32_dpp v40, v231, v12 quad_perm:[0,0,0,0] row_mask:0xf bank_mask:0xf
    v_and_b32_dpp v41, v231, v13 quad_perm:[0,0,0,0] row_mask:0xf bank_mask:0xf
    s_waitcnt vmcnt(30)
    v_mfma_f32_16x16x32_bf16 v[44:47], v[128:131], v[36:39], v[44:47]
    v_mfma_f32_16x16x32_bf16 v[48:51], v[136:139], v[36:39], v[48:51]
    v_mfma_f32_16x16x32_bf16 v[44:47], v[132:135], v[40:43], v[44:47]
    v_mfma_f32_16x16x32_bf16 v[48:51], v[140:143], v[40:43], v[48:51]
    s_xor_b32 s43, s67, 4096
    s_cmp_lt_u32 4, s70
    s_cselect_b32 s43, s43, 0x800000
    v_xor_b32 v220, s43, v56
    v_xor_b32 v221, s43, v57
    v_xor_b32 v222, s43, v58
    v_xor_b32 v223, s43, v59
    buffer_load_dwordx4 v[128:131], v220, s[16:19], 0 offen nt
    buffer_load_dwordx4 v[132:135], v221, s[16:19], 0 offen nt
    buffer_load_dwordx4 v[136:139], v222, s[16:19], 0 offen nt
    buffer_load_dwordx4 v[140:143], v223, s[16:19], 0 offen nt
    v_and_b32_dpp v232, v225, v12 quad_perm:[1,1,1,1] row_mask:0xf bank_mask:0xf
    v_and_b32_dpp v233, v225, v13 quad_perm:[1,1,1,1] row_mask:0xf bank_mask:0xf
    v_and_b32_dpp v238, v225, v14 quad_perm:[1,1,1,1] row_mask:0xf bank_mask:0xf
    v_and_b32_dpp v239, v225, v15 quad_perm:[1,1,1,1] row_mask:0xf bank_mask:0xf
    v_and_b32_dpp v234, v229, v14 quad_perm:[1,1,1,1] row_mask:0xf bank_mask:0xf
    v_and_b32_dpp v235, v229, v15 quad_perm:[1,1,1,1] row_mask:0xf bank_mask:0xf
    v_and_b32_dpp v236, v231, v12 quad_perm:[1,1,1,1] row_mask:0xf bank_mask:0xf
    v_and_b32_dpp v237, v231, v13 quad_perm:[1,1,1,1] row_mask:0xf bank_mask:0xf
    s_waitcnt vmcnt(30)
    v_mfma_f32_16x16x32_bf16 v[44:47], v[144:147], v[232:235], v[44:47]
    v_mfma_f32_16x16x32_bf16 v[48:51], v[152:155], v[232:235], v[48:51]
    v_mfma_f32_16x16x32_bf16 v[44:47], v[148:151], v[236:239], v[44:47]
    v_mfma_f32_16x16x32_bf16 v[48:51], v[156:159], v[236:239], v[48:51]
    s_xor_b32 s43, s67, 1052672
    s_cmp_lt_u32 5, s70
    s_cselect_b32 s43, s43, 0x800000
    v_xor_b32 v220, s43, v56
    v_xor_b32 v221, s43, v57
    v_xor_b32 v222, s43, v58
    v_xor_b32 v223, s43, v59
    buffer_load_dwordx4 v[144:147], v220, s[16:19], 0 offen nt
    buffer_load_dwordx4 v[148:151], v221, s[16:19], 0 offen nt
    buffer_load_dwordx4 v[152:155], v222, s[16:19], 0 offen nt
    buffer_load_dwordx4 v[156:159], v223, s[16:19], 0 offen nt
    v_and_b32_dpp v36, v225, v12 quad_perm:[2,2,2,2] row_mask:0xf bank_mask:0xf
    v_and_b32_dpp v37, v225, v13 quad_perm:[2,2,2,2] row_mask:0xf bank_mask:0xf
    v_and_b32_dpp v42, v225, v14 quad_perm:[2,2,2,2] row_mask:0xf bank_mask:0xf
    v_and_b32_dpp v43, v225, v15 quad_perm:[2,2,2,2] row_mask:0xf bank_mask:0xf
    v_and_b32_dpp v38, v229, v14 quad_perm:[2,2,2,2] row_mask:0xf bank_mask:0xf
    v_and_b32_dpp v39, v229, v15 quad_perm:[2,2,2,2] row_mask:0xf bank_mask:0xf
    v_and_b32_dpp v40, v231, v12 quad_perm:[2,2,2,2] row_mask:0xf bank_mask:0xf
    v_and_b32_dpp v41, v231, v13 quad_perm:[2,2,2,2] row_mask:0xf bank_mask:0xf
    s_waitcnt vmcnt(30)
    v_mfma_f32_16x16x32_bf16 v[44:47], v[160:163], v[36:39], v[44:47]
    v_mfma_f32_16x16x32_bf16 v[48:51], v[168:171], v[36:39], v[48:51]
    v_mfma_f32_16x16x32_bf16 v[44:47], v[164:167], v[40:43], v[44:47]
    v_mfma_f32_16x16x32_bf16 v[48:51], v[172:175], v[40:43], v[48:51]
    s_xor_b32 s43, s67, 6144
    s_cmp_lt_u32 6, s70
    s_cselect_b32 s43, s43, 0x800000
    v_xor_b32 v220, s43, v56
    v_xor_b32 v221, s43, v57
    v_xor_b32 v222, s43, v58
    v_xor_b32 v223, s43, v59
    buffer_load_dwordx4 v[160:163], v220, s[16:19], 0 offen nt
    buffer_load_dwordx4 v[164:167], v221, s[16:19], 0 offen nt
    buffer_load_dwordx4 v[168:171], v222, s[16:19], 0 offen nt
    buffer_load_dwordx4 v[172:175], v223, s[16:19], 0 offen nt
    v_and_b32_dpp v232, v225, v12 quad_perm:[3,3,3,3] row_mask:0xf bank_mask:0xf
    v_and_b32_dpp v233, v225, v13 quad_perm:[3,3,3,3] row_mask:0xf bank_mask:0xf
    v_and_b32_dpp v238, v225, v14 quad_perm:[3,3,3,3] row_mask:0xf bank_mask:0xf
    v_and_b32_dpp v239, v225, v15 quad_perm:[3,3,3,3] row_mask:0xf bank_mask:0xf
    v_and_b32_dpp v234, v229, v14 quad_perm:[3,3,3,3] row_mask:0xf bank_mask:0xf
    v_and_b32_dpp v235, v229, v15 quad_perm:[3,3,3,3] row_mask:0xf bank_mask:0xf
    v_and_b32_dpp v236, v231, v12 quad_perm:[3,3,3,3] row_mask:0xf bank_mask:0xf
    v_and_b32_dpp v237, v231, v13 quad_perm:[3,3,3,3] row_mask:0xf bank_mask:0xf
    s_waitcnt vmcnt(30)
    v_mfma_f32_16x16x32_bf16 v[44:47], v[176:179], v[232:235], v[44:47]
    v_mfma_f32_16x16x32_bf16 v[48:51], v[184:187], v[232:235], v[48:51]
    v_mfma_f32_16x16x32_bf16 v[44:47], v[180:183], v[236:239], v[44:47]
    v_mfma_f32_16x16x32_bf16 v[48:51], v[188:191], v[236:239], v[48:51]
    s_xor_b32 s43, s67, 1054720
    s_cmp_lt_u32 7, s70
    s_cselect_b32 s43, s43, 0x800000
    v_xor_b32 v220, s43, v56
    v_xor_b32 v221, s43, v57
    v_xor_b32 v222, s43, v58
    v_xor_b32 v223, s43, v59
    buffer_load_dwordx4 v[176:179], v220, s[16:19], 0 offen nt
    buffer_load_dwordx4 v[180:183], v221, s[16:19], 0 offen nt
    buffer_load_dwordx4 v[184:187], v222, s[16:19], 0 offen nt
    buffer_load_dwordx4 v[188:191], v223, s[16:19], 0 offen nt
    s_cmp_eq_u32 s90, 0
    s_cbranch_scc1 L_D
    s_waitcnt vmcnt(32)
    v_cmp_gt_i32 vcc, 0, v226
    v_lshlrev_b32 v3, 16, v226
    v_and_b32 v4, 0x7fff0000, v226
    s_mov_b32 s50, vcc_lo
    v_subrev_f32 v6, vcc_lo, v9
    v_cmp_lt_f32 vcc, 0, v6
    s_cbranch_vccnz L_rare_F
L_back_F:
    v_exp_f32 v6, v6
    s_cmp_eq_u32 s55, 0
    s_cbranch_scc1 L_nosw
    v_mov_b32_dpp v5, v3 quad_perm:[3,2,1,0] row_mask:0xf bank_mask:0xf
    v_mov_b32_dpp v3, v4 quad_perm:[3,2,1,0] row_mask:0xf bank_mask:0xf
    v_mov_b32 v4, v5
L_nosw:
    v_mul_f32 v3, v3, v6
    v_mul_f32 v4, v4, v6
    s_sub_i32 s47, s70, 4
    v_cmp_gt_i32 vcc, s70, v7
    v_cmp_gt_i32 s[50:51], s47, v7
    s_nop 1
    v_cndmask_b32 v3, 0, v3, vcc
    v_cndmask_b32 v4, 0, v4, s[50:51]
    v_cvt_pk_bf16_f32 v224, v3, v3
    v_cvt_pk_bf16_f32 v225, v4, v4
    v_add_f32 v8, v8, v3
    v_add_f32 v8, v8, v4
    v_mov_b32_dpp v228, v224 row_shr:4 row_mask:0xf bank_mask:0xf bound_ctrl:0
    v_mov_b32_dpp v230, v224 row_shl:4 row_mask:0xf bank_mask:0xf bound_ctrl:0
    v_mov_b32_dpp v229, v225 row_shr:4 row_mask:0xf bank_mask:0xf bound_ctrl:0
    v_mov_b32_dpp v231, v225 row_shl:4 row_mask:0xf bank_mask:0xf bound_ctrl:0
    v_add_f32_dpp v11, v8, v8 quad_perm:[1,0,3,2] row_mask:0xf bank_mask:0xf
    s_nop 1
    v_add_f32_dpp v11, v11, v11 quad_perm:[2,3,0,1] row_mask:0xf bank_mask:0xf
    s_nop 1
    v_add_f32_dpp v11, v11, v11 row_ror:4 row_mask:0xf bank_mask:0xf
    s_nop 1
    v_add_f32_dpp v11, v11, v11 row_ror:8 row_mask:0xf bank_mask:0xf
    v_mov_b32 v246, v9
    v_mov_b32 v54, 1
    v_readlane_b32 s50, v11, 0
    v_readlane_b32 s51, v11, 16
    v_readlane_b32 s52, v11, 32
    v_readlane_b32 s53, v11, 48
    s_nop 1
    v_mov_b32 v8, s50
    v_add_f32 v8, s51, v8
    v_mov_b32 v11, s52
    v_add_f32 v11, s53, v11
    v_add_f32 v8, v8, v11
    v_or_b32 v247, 1, v8
    s_cmp_eq_u32 s70, 0
    s_cbranch_scc1 L_done
    v_and_b32_dpp v36, v224, v12 quad_perm:[0,0,0,0] row_mask:0xf bank_mask:0xf
    v_and_b32_dpp v37, v224, v13 quad_perm:[0,0,0,0] row_mask:0xf bank_mask:0xf
    v_and_b32_dpp v42, v224, v14 quad_perm:[0,0,0,0] row_mask:0xf bank_mask:0xf
    v_and_b32_dpp v43, v224, v15 quad_perm:[0,0,0,0] row_mask:0xf bank_mask:0xf
    v_and_b32_dpp v38, v228, v14 quad_perm:[0,0,0,0] row_mask:0xf bank_mask:0xf
    v_and_b32_dpp v39, v228, v15 quad_perm:[0,0,0,0] row_mask:0xf bank_mask:0xf
    v_and_b32_dpp v40, v230, v12 quad_perm:[0,0,0,0] row_mask:0xf bank_mask:0xf
    v_and_b32_dpp v41, v230, v13 quad_perm:[0,0,0,0] row_mask:0xf bank_mask:0xf
    s_waitcnt vmcnt(28)
    v_mfma_f32_16x16x32_bf16 v[44:47], v[64:67], v[36:39], v[44:47]
    v_mfma_f32_16x16x32_bf16 v[48:51], v[72:75], v[36:39], v[48:51]
    v_mfma_f32_16x16x32_bf16 v[44:47], v[68:71], v[40:43], v[44:47]
    v_mfma_f32_16x16x32_bf16 v[48:51], v[76:79], v[40:43], v[48:51]
    s_cmp_eq_u32 s70, 1
    s_cbranch_scc1 L_done
    v_and_b32_dpp v232, v224, v12 quad_perm:[1,1,1,1] row_mask:0xf bank_mask:0xf
    v_and_b32_dpp v233, v224, v13 quad_perm:[1,1,1,1] row_mask:0xf bank_mask:0xf
    v_and_b32_dpp v238, v224, v14 quad_perm:[1,1,1,1] row_mask:0xf bank_mask:0xf
    v_and_b32_dpp v239, v224, v15 quad_perm:[1,1,1,1] row_mask:0xf bank_mask:0xf
    v_and_b32_dpp v234, v228, v14 quad_perm:[1,1,1,1] row_mask:0xf bank_mask:0xf
    v_and_b32_dpp v235, v228, v15 quad_perm:[1,1,1,1] row_mask:0xf bank_mask:0xf
    v_and_b32_dpp v236, v230, v12 quad_perm:[1,1,1,1] row_mask:0xf bank_mask:0xf
    v_and_b32_dpp v237, v230, v13 quad_perm:[1,1,1,1] row_mask:0xf bank_mask:0xf
    s_waitcnt vmcnt(24)
    v_mfma_f32_16x16x32_bf16 v[44:47], v[80:83], v[232:235], v[44:47]
    v_mfma_f32_16x16x32_bf16 v[48:51], v[88:91], v[232:235], v[48:51]
    v_mfma_f32_16x16x32_bf16 v[44:47], v[84:87], v[236:239], v[44:47]
    v_mfma_f32_16x16x32_bf16 v[48:51], v[92:95], v[236:239], v[48:51]
    s_cmp_eq_u32 s70, 2
    s_cbranch_scc1 L_done
    v_and_b32_dpp v36, v224, v12 quad_perm:[2,2,2,2] row_mask:0xf bank_mask:0xf
    v_and_b32_dpp v37, v224, v13 quad_perm:[2,2,2,2] row_mask:0xf bank_mask:0xf
    v_and_b32_dpp v42, v224, v14 quad_perm:[2,2,2,2] row_mask:0xf bank_mask:0xf
    v_and_b32_dpp v43, v224, v15 quad_perm:[2,2,2,2] row_mask:0xf bank_mask:0xf
    v_and_b32_dpp v38, v228, v14 quad_perm:[2,2,2,2] row_mask:0xf bank_mask:0xf
    v_and_b32_dpp v39, v228, v15 quad_perm:[2,2,2,2] row_mask:0xf bank_mask:0xf
    v_and_b32_dpp v40, v230, v12 quad_perm:[2,2,2,2] row_mask:0xf bank_mask:0xf
    v_and_b32_dpp v41, v230, v13 quad_perm:[2,2,2,2] row_mask:0xf bank_mask:0xf
    s_waitcnt vmcnt(20)
    v_mfma_f32_16x16x32_bf16 v[44:47], v[96:99], v[36:39], v[44:47]
    v_mfma_f32_16x16x32_bf16 v[48:51], v[104:107], v[36:39], v[48:51]
    v_mfma_f32_16x16x32_bf16 v[44:47], v[100:103], v[40:43], v[44:47]
    v_mfma_f32_16x16x32_bf16 v[48:51], v[108:111], v[40:43], v[48:51]
    s_cmp_eq_u32 s70, 3
    s_cbranch_scc1 L_done
    v_and_b32_dpp v232, v224, v12 quad_perm:[3,3,3,3] row_mask:0xf bank_mask:0xf
    v_and_b32_dpp v233, v224, v13 quad_perm:[3,3,3,3] row_mask:0xf bank_mask:0xf
    v_and_b32_dpp v238, v224, v14 quad_perm:[3,3,3,3] row_mask:0xf bank_mask:0xf
    v_and_b32_dpp v239, v224, v15 quad_perm:[3,3,3,3] row_mask:0xf bank_mask:0xf
    v_and_b32_dpp v234, v228, v14 quad_perm:[3,3,3,3] row_mask:0xf bank_mask:0xf
    v_and_b32_dpp v235, v228, v15 quad_perm:[3,3,3,3] row_mask:0xf bank_mask:0xf
    v_and_b32_dpp v236, v230, v12 quad_perm:[3,3,3,3] row_mask:0xf bank_mask:0xf
    v_and_b32_dpp v237, v230, v13 quad_perm:[3,3,3,3] row_mask:0xf bank_mask:0xf
    s_waitcnt vmcnt(16)
    v_mfma_f32_16x16x32_bf16 v[44:47], v[112:115], v[232:235], v[44:47]
    v_mfma_f32_16x16x32_bf16 v[48:51], v[120:123], v[232:235], v[48:51]
    v_mfma_f32_16x16x32_bf16 v[44:47], v[116:119], v[236:239], v[44:47]
    v_mfma_f32_16x16x32_bf16 v[48:51], v[124:127], v[236:239], v[48:51]
    s_cmp_eq_u32 s70, 4
    s_cbranch_scc1 L_done
    v_and_b32_dpp v36, v225, v12 quad_perm:[0,0,0,0] row_mask:0xf bank_mask:0xf
    v_and_b32_dpp v37, v225, v13 quad_perm:[0,0,0,0] row_mask:0xf bank_mask:0xf
    v_and_b32_dpp v42, v225, v14 quad_perm:[0,0,0,0] row_mask:0xf bank_mask:0xf
    v_and_b32_dpp v43, v225, v15 quad_perm:[0,0,0,0] row_mask:0xf bank_mask:0xf
    v_and_b32_dpp v38, v229, v14 quad_perm:[0,0,0,0] row_mask:0xf bank_mask:0xf
    v_and_b32_dpp v39, v229, v15 quad_perm:[0,0,0,0] row_mask:0xf bank_mask:0xf
    v_and_b32_dpp v40, v231, v12 quad_perm:[0,0,0,0] row_mask:0xf bank_mask:0xf
    v_and_b32_dpp v41, v231, v13 quad_perm:[0,0,0,0] row_mask:0xf bank_mask:0xf
    s_waitcnt vmcnt(12)
    v_mfma_f32_16x16x32_bf16 v[44:47], v[128:131], v[36:39], v[44:47]
    v_mfma_f32_16x16x32_bf16 v[48:51], v[136:139], v[36:39], v[48:51]
    v_mfma_f32_16x16x32_bf16 v[44:47], v[132:135], v[40:43], v[44:47]
    v_mfma_f32_16x16x32_bf16 v[48:51], v[140:143], v[40:43], v[48:51]
    s_cmp_eq_u32 s70, 5
    s_cbranch_scc1 L_done
    v_and_b32_dpp v232, v225, v12 quad_perm:[1,1,1,1] row_mask:0xf bank_mask:0xf
    v_and_b32_dpp v233, v225, v13 quad_perm:[1,1,1,1] row_mask:0xf bank_mask:0xf
    v_and_b32_dpp v238, v225, v14 quad_perm:[1,1,1,1] row_mask:0xf bank_mask:0xf
    v_and_b32_dpp v239, v225, v15 quad_perm:[1,1,1,1] row_mask:0xf bank_mask:0xf
    v_and_b32_dpp v234, v229, v14 quad_perm:[1,1,1,1] row_mask:0xf bank_mask:0xf
    v_and_b32_dpp v235, v229, v15 quad_perm:[1,1,1,1] row_mask:0xf bank_mask:0xf
    v_and_b32_dpp v236, v231, v12 quad_perm:[1,1,1,1] row_mask:0xf bank_mask:0xf
    v_and_b32_dpp v237, v231, v13 quad_perm:[1,1,1,1] row_mask:0xf bank_mask:0xf
    s_waitcnt vmcnt(8)
    v_mfma_f32_16x16x32_bf16 v[44:47], v[144:147], v[232:235], v[44:47]
    v_mfma_f32_16x16x32_bf16 v[48:51], v[152:155], v[232:235], v[48:51]
    v_mfma_f32_16x16x32_bf16 v[44:47], v[148:151], v[236:239], v[44:47]
    v_mfma_f32_16x16x32_bf16 v[48:51], v[156:159], v[236:239], v[48:51]
    s_cmp_eq_u32 s70, 6
    s_cbranch_scc1 L_done
    v_and_b32_dpp v36, v225, v12 quad_perm:[2,2,2,2] row_mask:0xf bank_mask:0xf
    v_and_b32_dpp v37, v225, v13 quad_perm:[2,2,2,2] row_mask:0xf bank_mask:0xf
    v_and_b32_dpp v42, v225, v14 quad_perm:[2,2,2,2] row_mask:0xf bank_mask:0xf
    v_and_b32_dpp v43, v225, v15 quad_perm:[2,2,2,2] row_mask:0xf bank_mask:0xf
    v_and_b32_dpp v38, v229, v14 quad_perm:[2,2,2,2] row_mask:0xf bank_mask:0xf
    v_and_b32_dpp v39, v229, v15 quad_perm:[2,2,2,2] row_mask:0xf bank_mask:0xf
    v_and_b32_dpp v40, v231, v12 quad_perm:[2,2,2,2] row_mask:0xf bank_mask:0xf
    v_and_b32_dpp v41, v231, v13 quad_perm:[2,2,2,2] row_mask:0xf bank_mask:0xf
    s_waitcnt vmcnt(4)
    v_mfma_f32_16x16x32_bf16 v[44:47], v[160:163], v[36:39], v[44:47]
    v_mfma_f32_16x16x32_bf16 v[48:51], v[168:171], v[36:39], v[48:51]
    v_mfma_f32_16x16x32_bf16 v[44:47], v[164:167], v[40:43], v[44:47]
    v_mfma_f32_16x16x32_bf16 v[48:51], v[172:175], v[40:43], v[48:51]
    s_cmp_eq_u32 s70, 7
    s_cbranch_scc1 L_done
    v_and_b32_dpp v232, v225, v12 quad_perm:[3,3,3,3] row_mask:0xf bank_mask:0xf
    v_and_b32_dpp v233, v225, v13 quad_perm:[3,3,3,3] row_mask:0xf bank_mask:0xf
    v_and_b32_dpp v238, v225, v14 quad_perm:[3,3,3,3] row_mask:0xf bank_mask:0xf
    v_and_b32_dpp v239, v225, v15 quad_perm:[3,3,3,3] row_mask:0xf bank_mask:0xf
    v_and_b32_dpp v234, v229, v14 quad_perm:[3,3,3,3] row_mask:0xf bank_mask:0xf
    v_and_b32_dpp v235, v229, v15 quad_perm:[3,3,3,3] row_mask:0xf bank_mask:0xf
    v_and_b32_dpp v236, v231, v12 quad_perm:[3,3,3,3] row_mask:0xf bank_mask:0xf
    v_and_b32_dpp v237, v231, v13 quad_perm:[3,3,3,3] row_mask:0xf bank_mask:0xf
    s_waitcnt vmcnt(0)
    v_mfma_f32_16x16x32_bf16 v[44:47], v[176:179], v[232:235], v[44:47]
    v_mfma_f32_16x16x32_bf16 v[48:51], v[184:187], v[232:235], v[48:51]
    v_mfma_f32_16x16x32_bf16 v[44:47], v[180:183], v[236:239], v[44:47]
    v_mfma_f32_16x16x32_bf16 v[48:51], v[188:191], v[236:239], v[48:51]
L_done:
    s_nop 7
    v_add_f32_dpp v244, v48, v44 row_shl:8 row_mask:0xf bank_mask:0x3
    v_add_f32_dpp v245, v49, v45 row_shl:8 row_mask:0xf bank_mask:0x3
    v_add_f32_dpp v244, v46, v50 row_shr:8 row_mask:0xf bank_mask:0xc
    v_add_f32_dpp v245, v47, v51 row_shr:8 row_mask:0xf bank_mask:0xc
    buffer_store_dwordx4 v[244:247], v2, s[28:31], s69 offen sc1
    buffer_load_dwordx4 v[192:195], v2, s[28:31], s94 offen sc1
    buffer_load_dwordx4 v[196:199], v2, s[28:31], s95 offen sc1
    buffer_load_dwordx4 v[200:203], v2, s[28:31], s96 offen sc1
    buffer_load_dwordx4 v[204:207], v2, s[28:31], s97 offen sc1
    buffer_load_dwordx4 v[208:211], v2, s[28:31], s98 offen sc1
    buffer_load_dwordx4 v[212:215], v2, s[28:31], s99 offen sc1
    buffer_load_dwordx4 v[216:219], v2, s[28:31], s100 offen sc1
    s_mov_b64 exec, 1
    buffer_atomic_add v54, off, s[60:63], s49 offset:4 sc0
    s_mov_b64 exec, -1
    s_waitcnt vmcnt(1)
L_chk:
    v_and_b32 v11, v195, v199
    v_and_b32 v5, v203, v207
    v_and_b32 v11, v11, v211
    v_and_b32 v5, v5, v215
    v_and_b32 v11, v11, v219
    v_and_b32 v11, v11, v5
    v_and_b32 v11, 1, v11
    v_cmp_eq_u32 vcc, 0, v11
    s_cbranch_vccnz L_miss
    v_min3_f32 v3, v246, v194, v198
    v_min3_f32 v4, v202, v206, v210
    v_min3_f32 v3, v3, v214, v218
    v_min_f32 v3, v3, v4
    v_sub_f32 v246, v3, v246
    v_sub_f32 v194, v3, v194
    v_sub_f32 v198, v3, v198
    v_sub_f32 v202, v3, v202
    v_sub_f32 v206, v3, v206
    v_sub_f32 v210, v3, v210
    v_sub_f32 v214, v3, v214
    v_sub_f32 v218, v3, v218
    v_exp_f32 v246, v246
    v_exp_f32 v194, v194
    v_exp_f32 v198, v198
    v_exp_f32 v202, v202
    v_exp_f32 v206, v206
    v_exp_f32 v210, v210
    v_exp_f32 v214, v214
    v_exp_f32 v218, v218
    v_mul_f32 v5, v247, v246
    v_mul_f32 v6, v195, v194
    v_fmac_f32 v5, v199, v198
    v_fmac_f32 v6, v203, v202
    v_fmac_f32 v5, v207, v206
    v_fmac_f32 v6, v211, v210
    v_fmac_f32 v5, v215, v214
    v_fmac_f32 v6, v219, v218
    v_add_f32 v5, v5, v6
    v_mul_f32 v3, v244, v246
    v_rcp_f32 v5, v5
    v_mul_f32 v4, v245, v246
    v_fmac_f32 v3, v192, v194
    v_fmac_f32 v4, v193, v194
    v_fmac_f32 v3, v196, v198
    v_fmac_f32 v4, v197, v198
    v_fmac_f32 v3, v200, v202
    v_fmac_f32 v4, v201, v202
    v_fmac_f32 v3, v204, v206
    v_fmac_f32 v4, v205, v206
    v_fmac_f32 v3, v208, v210
    v_fmac_f32 v4, v209, v210
    v_fmac_f32 v3, v212, v214
    v_fmac_f32 v4, v213, v214
    v_fmac_f32 v3, v216, v218
    v_fmac_f32 v4, v217, v218
    v_mul_f32 v3, v3, v5
    v_mul_f32 v4, v4, v5
    v_cvt_pk_bf16_f32 v3, v3, v4
    buffer_store_short v3, v1, s[32:35], 0 offen
    buffer_store_short_d16_hi v3, v1, s[32:35], 0 offen offset:16
L_end:
    s_endpgm
L_miss:
    s_waitcnt vmcnt(0)
    v_readfirstlane_b32 s48, v54
    s_cmp_lg_u32 s48, 7
    s_cbranch_scc1 L_end
    buffer_load_dwordx4 v[192:195], v2, s[28:31], s94 offen sc1
    buffer_load_dwordx4 v[196:199], v2, s[28:31], s95 offen sc1
    buffer_load_dwordx4 v[200:203], v2, s[28:31], s96 offen sc1
    buffer_load_dwordx4 v[204:207], v2, s[28:31], s97 offen sc1
    buffer_load_dwordx4 v[208:211], v2, s[28:31], s98 offen sc1
    buffer_load_dwordx4 v[212:215], v2, s[28:31], s99 offen sc1
    buffer_load_dwordx4 v[216:219], v2, s[28:31], s100 offen sc1
    s_waitcnt vmcnt(0)
    s_branch L_chk
L_ctlA:
    s_cmp_lg_u32 s42, 1
    s_cbranch_scc1 L_c2A
    v_mov_b32 v53, 1
    s_mov_b64 exec, 1
    buffer_atomic_add v53, off, s[60:63], s49 sc0
    s_mov_b64 exec, -1
    s_branch L_retA
L_c2A:
    s_cmp_lg_u32 s42, 2
    s_cbranch_scc1 L_c3A
    s_waitcnt vmcnt(32)
L_spinA:
    v_readfirstlane_b32 s47, v55
    s_cmp_ge_u32 s47, 1
    s_cbranch_scc1 L_retA
    s_mov_b64 exec, 1
    buffer_load_dword v55, off, s[36:39], s64 sc0 sc1
    s_mov_b64 exec, -1
    s_waitcnt vmcnt(0)
    s_branch L_spinA
L_c3A:
    s_mov_b64 exec, 1
    s_cmp_lg_u32 s42, 3
    s_cbranch_scc1 L_c4A
    buffer_load_dword v55, off, s[36:39], s64 sc0 sc1
    s_mov_b64 exec, -1
    s_branch L_retA
L_c4A:
    s_mov_b32 s46, 3
    v_mov_b32 v54, 1
    buffer_store_dword v54, off, s[36:39], s64 sc0 sc1
    s_mov_b64 exec, -1
    s_branch L_retA
L_ctlC:
    s_cmp_lg_u32 s42, 1
    s_cbranch_scc1 L_c2C
    v_mov_b32 v53, 1
    s_mov_b64 exec, 1
    buffer_atomic_add v53, off, s[60:63], s49 offset:8 sc0
    s_mov_b64 exec, -1
    s_branch L_retC
L_c2C:
    s_cmp_lg_u32 s42, 2
    s_cbranch_scc1 L_c3C
    s_waitcnt vmcnt(32)
L_spinC:
    v_readfirstlane_b32 s47, v55
    s_cmp_ge_u32 s47, 8
    s_cbranch_scc1 L_retC
    s_mov_b64 exec, 1
    buffer_load_dword v55, off, s[36:39], s64 offset:128 sc0 sc1
    s_mov_b64 exec, -1
    s_waitcnt vmcnt(0)
    s_branch L_spinC
L_c3C:
    s_mov_b64 exec, 1
    s_cmp_lg_u32 s42, 3
    s_cbranch_scc1 L_c4C
    buffer_load_dword v55, off, s[36:39], s64 offset:128 sc0 sc1
    s_mov_b64 exec, -1
    s_branch L_retC
L_c4C:
    s_mov_b32 s46, 3
    v_mov_b32 v54, 1
    buffer_atomic_add v54, off, s[36:39], s64 offset:128
    s_mov_b64 exec, -1
    s_branch L_retC
L_swV:
    s_mov_b32 s44, s41
    s_mov_b32 s16, s20
    s_mov_b32 s17, s21
    v_mov_b32 v56, v60
    v_mov_b32 v57, v61
    v_mov_b32 v58, v62
    v_mov_b32 v59, v63
    s_mov_b32 s90, 1
    s_branch L_retB
L_pairB:
    s_lshl_b32 s47, s47, 1
    s_add_u32 s93, s47, 1
    buffer_load_dword v195, v251, s[28:31], 0 offen
    s_branch L_pretB
L_holdB:
    buffer_load_dword v195, v251, s[28:31], 0 offen
    buffer_load_dword v195, v251, s[28:31], 0 offen
    v_mov_b32 v250, v243
    v_mov_b32 v196, v224
    v_mov_b32 v197, v225
    v_mov_b32 v198, v226
    v_mov_b32 v199, v227
    s_branch L_hretB
L_pairD:
    s_lshl_b32 s47, s47, 1
    s_add_u32 s93, s47, 1
    buffer_load_dword v195, v251, s[28:31], 0 offen
    s_branch L_pretD
L_tail:
    s_sub_u32 s47, s47, 60
    s_lshl_b32 s47, s47, 3
    s_lshr_b64 s[88:89], s[88:89], s47
    s_and_b32 s47, s88, 7
    s_add_u32 s47, s47, 60
    s_bfe_u32 s55, s88, 0x10003
    s_mul_i32 s71, s55, 0x101800
    s_bfe_u32 s70, s88, 0x40004
    s_add_u32 s54, s49, 4
    s_mov_b32 s90, 1
    s_branch L_retD
L_rare_D:
    v_exp_f32 v11, -v6
    v_mov_b32 v9, s50
    v_mov_b32 v6, 0
    s_nop 7
    v_mul_f32 v8, v8, v11
    v_mul_f32 v44, v44, v11
    v_mul_f32 v48, v48, v11
    v_mul_f32 v45, v45, v11
    v_mul_f32 v49, v49, v11
    v_mul_f32 v46, v46, v11
    v_mul_f32 v50, v50, v11
    v_mul_f32 v47, v47, v11
    v_mul_f32 v51, v51, v11
    s_branch L_back_D
L_rare_F:
    v_exp_f32 v11, -v6
    v_mov_b32 v9, s50
    v_mov_b32 v6, 0
    s_nop 7
    v_mul_f32 v8, v8, v11
    v_mul_f32 v44, v44, v11
    v_mul_f32 v48, v48, v11
    v_mul_f32 v45, v45, v11
    v_mul_f32 v49, v49, v11
    v_mul_f32 v46, v46, v11
    v_mul_f32 v50, v50, v11
    v_mul_f32 v47, v47, v11
    v_mul_f32 v51, v51, v11
    s_branch L_back_F
L_codeend:
.section .rodata,"a"
.p2align 6
.amdhsa_kernel standalone__gqa_softmax__decode_kernel
  .amdhsa_next_free_vgpr 253
  .amdhsa_next_free_sgpr 102
  .amdhsa_accum_offset 256
  .amdhsa_group_segment_fixed_size 0
  .amdhsa_kernarg_size 48
  .amdhsa_user_sgpr_count 2
  .amdhsa_user_sgpr_kernarg_segment_ptr 1
  .amdhsa_system_sgpr_workgroup_id_x 1
.end_amdhsa_kernel
```
